```python
import torch

def _softmax(x, axis=-1):
    return torch.softmax(x, dim=axis)
def _gelu(x):
    return torch.nn.functional.gelu(x, approximate="tanh")
def _silu(x):
    return torch.nn.functional.silu(x)
def _sigmoid(x):
    return torch.sigmoid(x)
def _layernorm(x, axis=-1, eps=1e-5):
    m = x.mean(dim=axis, keepdim=True)
    v = x.var(dim=axis, keepdim=True, unbiased=False)
    return (x - m) / torch.sqrt(v + eps)
def _scatter_add(tgt, idx, src, axis=0):
    return tgt.clone().index_add_(axis, idx, src)
def _segment_sum(src, seg, n):
    out = torch.zeros((n,) + src.shape[1:], dtype=src.dtype)
    return out.index_add_(0, seg, src)
def _pad(x, pw):
    flat = tuple(v for pair in reversed(pw) for v in pair)
    return torch.nn.functional.pad(x, flat)

kernel_name = 'recurrent_scan__spectral_fnet__glu_gated_swiglu__prompt'

def setup_inputs():

    _w = (lambda a: (lambda t: t.to(torch.bfloat16) if t.is_floating_point() else t)(torch.as_tensor(a)))
    def _A_setup():
        B, S, D = 1, 2048, 512
        ns = torch.arange(S)[:, None] * torch.arange(S)[None, :]
        nd = torch.arange(D)[:, None] * torch.arange(D)[None, :]
        Ws_re = torch.cos(-2.0 * torch.pi * ns / S).to(float)
        Ws_im = torch.sin(-2.0 * torch.pi * ns / S).to(float)
        Wd_re = torch.cos(-2.0 * torch.pi * nd / D).to(float)
        Wd_im = torch.sin(-2.0 * torch.pi * nd / D).to(float)
        return {
            "x": _w((lambda *s: torch.randn(*s, dtype=torch.bfloat16) * 0.05)(B, S, D)),
            "dft_seq_re": _w(Ws_re),
            "dft_seq_im": _w(Ws_im),
            "dft_hid_re": _w(Wd_re),
            "dft_hid_im": _w(Wd_im),
        }
    _A_in = _A_setup()

    def _B_setup():
        B, S, D, F = 1, 2048, 512, 1376
        return {
            "x": _w((lambda *s: torch.randn(*s, dtype=torch.bfloat16) * 0.05)(B, S, D)),
            "w1": _w((lambda *s: torch.randn(*s, dtype=torch.bfloat16) * 0.05)(D, F) * (2.0 / D) ** 0.5),
            "w3": _w((lambda *s: torch.randn(*s, dtype=torch.bfloat16) * 0.05)(D, F) * (2.0 / D) ** 0.5),
            "w2": _w((lambda *s: torch.randn(*s, dtype=torch.bfloat16) * 0.05)(F, D) * (2.0 / F) ** 0.5),
        }
    _B_in = _B_setup()

    return {
        "A_x": _A_in["x"],
        "A_dft_seq_re": _A_in["dft_seq_re"],
        "A_dft_seq_im": _A_in["dft_seq_im"],
        "A_dft_hid_re": _A_in["dft_hid_re"],
        "A_dft_hid_im": _A_in["dft_hid_im"],
        "B_x": _B_in["x"],
        "B_w1": _B_in["w1"],
        "B_w3": _B_in["w3"],
        "B_w2": _B_in["w2"],
    }

def reference(A_x, A_dft_seq_re, A_dft_seq_im, A_dft_hid_re, A_dft_hid_im, B_x, B_w1, B_w3, B_w2):
    def _A_ref(x, dft_seq_re, dft_seq_im, dft_hid_re, dft_hid_im):
        a = torch.einsum("bsd,ed->bse", x, dft_hid_re)
        b = torch.einsum("bsd,ed->bse", x, dft_hid_im)
        y = torch.einsum("ts,bse->bte", dft_seq_re, a) - torch.einsum("ts,bse->bte", dft_seq_im, b)
        return y

    def _B_ref(x, w1, w3, w2):
        gate = torch.einsum("bsd,df->bsf", x, w1)
        up = torch.einsum("bsd,df->bsf", x, w3)
        h = _silu(gate) * up
        out = torch.einsum("bsf,fd->bsd", h, w2)
        return out

    x = A_x
    xn = _layernorm(x, axis=-1)
    s = _A_ref(xn, A_dft_seq_re, A_dft_seq_im, A_dft_hid_re, A_dft_hid_im)
    g = _silu(_B_ref(xn, B_w1, B_w3, B_w2))
    return x + s * g
```

```asm
; @launch grid=(256,1,1) block=(512,1,1) lds=163840
.amdgcn_target "amdgcn-amd-amdhsa--gfx950"
.text
.globl recurrent_scan__spectral_fnet__glu_gated_swiglu__prompt_kernel
.p2align 8
.type recurrent_scan__spectral_fnet__glu_gated_swiglu__prompt_kernel,@function
recurrent_scan__spectral_fnet__glu_gated_swiglu__prompt_kernel:
    s_load_dwordx2 s[4:5], s[0:1], 0
    s_load_dwordx4 s[8:11], s[0:1], 48
    s_load_dwordx4 s[12:15], s[0:1], 24
    s_load_dwordx4 s[64:67], s[0:1], 64
    s_load_dwordx4 s[68:71], s[0:1], 80
    s_cmp_ge_u32 s2, 256
    s_cbranch_scc1 k_exit
    v_lshrrev_b32 v1, 6, v0
    v_and_b32 v200, 63, v0
    v_readfirstlane_b32 s3, v1
    s_and_b32 s49, s2, 1
    s_bfe_u32 s16, s2, 0x30003
    s_lshr_b32 s23, s2, 6
    s_bfe_u32 s17, s2, 0x20001
    s_lshl2_add_u32 s17, s23, s17
    s_lshl1_add_u32 s40, s23, s16
    s_and_b32 s48, s40, 1
    s_and_b32 s40, s40, 6
    s_and_b32 s18, s3, 3
    s_lshl3_add_u32 s20, s49, s16
    s_and_b32 s21, s16, 4
    s_add_u32 s21, s21, s16
    s_lshl2_add_u32 s21, s49, s21
    s_mul_i32 s19, s17, 112
    s_min_u32 s19, s19, 1264
    s_mul_i32 s22, s17, 96
    s_sub_u32 s22, s22, 1248
    s_cmp_lt_u32 s17, 13
    s_cselect_b32 s16, s20, s21
    s_cselect_b32 s19, s19, s22
    s_cselect_b32 s42, 15, 16
    s_cmp_lt_u32 s3, 4
    s_cbranch_scc1 k_c
    s_lshr_b32 s43, s18, 1
    s_and_b32 s45, s18, 1
    s_lshl1_add_u32 s20, s16, s43
    s_lshl_b32 s21, s45, 10
    s_add_u32 s20, s20, s21
    s_lshl2_add_u32 s21, s16, s18
    s_cmp_lt_u32 s17, 13
    s_cselect_b32 s20, s20, s21
    s_lshl_b32 s20, s20, 10
    v_lshrrev_b32 v2, 3, v200
    v_and_b32 v3, 7, v200
    v_lshrrev_b32 v4, 4, v200
    v_xor_b32 v3, v3, v4
    v_lshlrev_b32 v3, 4, v3
    v_lshl_add_u32 v100, v2, s42, v3
    s_lshl_b32 s21, 8, s42
    s_sub_u32 s21, s21, 0x400
    v_xor_b32 v4, 64, v100
    v_add_u32 v101, s21, v4
    s_lshl_b32 s21, s21, 1
    v_add_u32 v102, s21, v100
    v_add_u32 v103, s21, v101
    s_lshl_b32 s22, s18, 12
    s_mov_b32 m0, s22
    s_lshl_b32 s52, s40, 7
    s_add_u32 s52, s52, s20
    s_mov_b32 s26, 0x200000
    s_mov_b32 s27, 0x20000
    s_waitcnt lgkmcnt(0)
    s_mov_b32 s24, s4
    s_and_b32 s25, s5, 0xffff
    buffer_load_dwordx4 v100, s[24:27], s52 offen offset:0 lds
    buffer_load_dwordx4 v101, s[24:27], s52 offen offset:1024 lds
    buffer_load_dwordx4 v102, s[24:27], s52 offen offset:2048 lds
    buffer_load_dwordx4 v103, s[24:27], s52 offen offset:3072 lds
    s_movk_i32 s46, 4682
    s_movk_i32 s47, 2752
    s_movk_i32 s44, 224
    s_cmp_ge_u32 s17, 13
    s_cmovk_i32 s46, 5462
    s_cmovk_i32 s47, 1024
    s_cmovk_i32 s44, 192
    s_cselect_b64 s[8:9], s[12:13], s[8:9]
    s_cselect_b64 s[10:11], s[14:15], s[10:11]
    s_cmp_lt_u32 s18, 2
    s_cselect_b64 s[28:29], s[8:9], s[10:11]
    s_and_b32 s29, s29, 0xffff
    s_lshl_b32 s30, s47, 9
    s_mov_b32 s31, 0x20000
    v_mul_u32_u24 v2, s46, v200
    s_lshl_b32 s46, s46, 6
    s_sub_u32 s21, s47, s44
    v_lshlrev_b32 v4, 4, v200
    v_add_u32 v5, 0x1000, v4
    s_lshl_b32 s45, s45, 5
    s_mul_i32 s36, s45, s47
    s_lshl1_add_u32 s36, s19, s36
    s_mul_i32 s37, s45, s44
    s_mul_i32 s43, s43, 14464
    s_add_u32 s37, s37, s43
    s_add_u32 s37, s37, 49152
    s_mul_i32 s53, s40, s47
    s_lshl_b32 s53, s53, 6
    s_add_u32 s53, s53, s36
    s_mov_b32 m0, s37
    s_add_u32 s41, s40, 1
    v_lshrrev_b32 v3, 16, v2
    v_add_u32 v2, s46, v2
    v_mad_u32_u24 v104, v3, s21, v4
    buffer_load_dwordx4 v104, s[28:31], s53 offen offset:0 lds
    v_lshrrev_b32 v3, 16, v2
    v_add_u32 v2, s46, v2
    v_mad_u32_u24 v105, v3, s21, v4
    buffer_load_dwordx4 v105, s[28:31], s53 offen offset:1024 lds
    v_lshrrev_b32 v3, 16, v2
    v_add_u32 v2, s46, v2
    v_mad_u32_u24 v106, v3, s21, v4
    buffer_load_dwordx4 v106, s[28:31], s53 offen offset:2048 lds
    v_lshrrev_b32 v3, 16, v2
    v_add_u32 v2, s46, v2
    v_mad_u32_u24 v107, v3, s21, v4
    buffer_load_dwordx4 v107, s[28:31], s53 offen offset:3072 lds
    s_add_u32 m0, s37, 0x1000
    v_lshrrev_b32 v3, 16, v2
    v_add_u32 v2, s46, v2
    v_mad_u32_u24 v108, v3, s21, v5
    buffer_load_dwordx4 v108, s[28:31], s53 offen offset:0 lds
    v_lshrrev_b32 v3, 16, v2
    v_add_u32 v2, s46, v2
    v_mad_u32_u24 v109, v3, s21, v5
    buffer_load_dwordx4 v109, s[28:31], s53 offen offset:1024 lds
    s_cmp_ge_u32 s17, 13
    s_cbranch_scc1 ld
    v_lshrrev_b32 v3, 16, v2
    v_add_u32 v2, s46, v2
    v_mad_u32_u24 v110, v3, s21, v5
    buffer_load_dwordx4 v110, s[28:31], s53 offen offset:2048 lds
lm:
    s_mov_b64 s[6:7], s[70:71]
    s_and_b32 s52, s2, 7
    s_lshr_b32 s53, s2, 3
    s_and_b32 s70, s52, 7
    s_lshl_b32 s70, s70, 2
    s_and_b32 s23, s53, 3
    s_add_u32 s70, s70, s23
    s_lshr_b32 s71, s52, 3
    s_lshl_b32 s71, s71, 3
    s_lshr_b32 s23, s53, 2
    s_add_u32 s71, s71, s23
    s_mul_i32 s77, s71, 11
    s_mul_i32 s23, s70, 2
    s_add_u32 s77, s77, s23
    s_mul_i32 s23, s77, 2979
    s_lshr_b32 s23, s23, 16
    s_mul_i32 s23, s23, 22
    s_sub_u32 s77, s77, s23
    s_mov_b32 s74, s77
    s_and_b32 s72, s3, 1
    s_bfe_u32 s73, s3, 0x10001
    s_lshl_b32 s76, s73, 20
    s_lshl_b32 s23, s70, 10
    s_add_u32 s76, s76, s23
    s_lshl_b32 s23, s71, 7
    s_add_u32 s76, s76, s23
    s_lshl_b32 s23, s72, 6
    s_add_u32 s76, s76, s23
    s_mov_b32 s56, s6
    s_and_b32 s57, s7, 0xffff
    s_mov_b32 s58, 0x10000000
    s_mov_b32 s59, 0x00020000
    s_mov_b32 s60, s68
    s_and_b32 s61, s69, 0xffff
    s_mov_b32 s62, 0x100
    s_mov_b32 s63, 0x00020000
    s_mov_b32 s32, s64
    s_and_b32 s33, s65, 0xffff
    s_mov_b32 s34, 0x158000
    s_mov_b32 s35, 0x00020000
    s_mov_b32 s44, s66
    s_and_b32 s45, s67, 0xffff
    s_mov_b32 s46, 0x200000
    s_mov_b32 s47, 0x00020000
    v_mov_b32 v98, 0
    v_mov_b32 v93, 161616
    ds_write_b32 v93, v98
    v_lshrrev_b32 v204, 3, v200
    v_and_b32 v205, 7, v200
    v_bfe_u32 v206, v200, 4, 1
    v_lshlrev_b32 v206, 2, v206
    v_xor_b32 v205, v205, v206
    v_lshlrev_b32 v204, 10, v204
    v_lshl_add_u32 v220, v205, 4, v204
    v_add_u32 v221, 7168, v220
    v_add_u32 v222, 14336, v220
    v_add_u32 v223, 21504, v220
    v_and_b32 v204, 31, v200
    v_lshrrev_b32 v205, 5, v200
    s_cmp_lt_u32 s71, 4
    s_cselect_b32 s38, 0, 0x80000000
    s_lshl_b32 s21, s73, 10
    s_add_u32 s21, s21, s70
    v_lshl_add_u32 v209, v204, 5, s21
    v_lshlrev_b32 v210, 2, v205
    v_mul_u32_u24 v210, v210, v209
    s_mov_b32 s42, 0x3a000000
    v_mov_b32 v90, v209
    v_mov_b32 v91, v210
    v_lshlrev_b32 v225, 15, v204
    v_lshl_add_u32 v225, v205, 4, v225
    s_mov_b32 s39, s49
    s_mul_i32 s23, s39, 7168
    s_add_u32 s23, s23, 49152
    s_lshl_b32 s21, s18, 5
    s_add_u32 s23, s23, s21
    v_lshrrev_b32 v205, 5, v200
    v_bfe_u32 v206, v200, 2, 2
    v_lshl_add_u32 v206, v205, 3, v206
    v_mul_u32_u24 v206, 224, v206
    v_and_b32 v207, 3, v200
    v_lshl_add_u32 v206, v207, 3, v206
    v_bfe_u32 v207, v200, 4, 1
    v_mul_u32_u24 v207, 14464, v207
    v_add3_u32 v112, v206, v207, s23
    s_add_u32 s21, s40, s48
    s_lshl_b32 s21, s21, 1
    s_add_u32 s39, s39, s21
    s_lshl_b32 s21, s17, 4
    s_add_u32 s39, s39, s21
    s_lshl_b32 s39, s39, 10
    s_lshl_b32 s21, s18, 7
    s_add_u32 s39, s39, s21
    s_add_u32 s39, s39, 0x910000
    s_mov_b32 s43, 0x3f803f80
    v_lshlrev_b32 v97, 2, v200
    v_mad_u32_u24 v4, v90, 0, v91
    v_mad_u32_u24 v5, v90, 1, v91
    v_mad_u32_u24 v6, v90, 2, v91
    v_mad_u32_u24 v7, v90, 3, v91
    v_and_b32 v4, 0x7ff, v4
    v_and_b32 v5, 0x7ff, v5
    v_and_b32 v6, 0x7ff, v6
    v_and_b32 v7, 0x7ff, v7
    v_cvt_f32_u32 v4, v4
    v_cvt_f32_u32 v5, v5
    v_cvt_f32_u32 v6, v6
    v_cvt_f32_u32 v7, v7
    v_mul_f32 v4, s42, v4
    v_mul_f32 v5, s42, v5
    v_mul_f32 v6, s42, v6
    v_mul_f32 v7, s42, v7
    v_cos_f32 v8, v4
    v_cos_f32 v9, v5
    v_cos_f32 v10, v6
    v_cos_f32 v11, v7
    v_sin_f32 v4, v4
    v_sin_f32 v5, v5
    v_sin_f32 v6, v6
    v_sin_f32 v7, v7
    v_cvt_pk_bf16_f32 v8, v8, v4
    v_cvt_pk_bf16_f32 v9, v9, v5
    v_cvt_pk_bf16_f32 v10, v10, v6
    v_cvt_pk_bf16_f32 v11, v11, v7
    v_xor_b32 v128, s38, v8
    v_xor_b32 v129, s38, v9
    v_xor_b32 v130, s38, v10
    v_xor_b32 v131, s38, v11
    v_mad_u32_u24 v4, v90, 8, v91
    v_mad_u32_u24 v5, v90, 9, v91
    v_mad_u32_u24 v6, v90, 10, v91
    v_mad_u32_u24 v7, v90, 11, v91
    v_and_b32 v4, 0x7ff, v4
    v_and_b32 v5, 0x7ff, v5
    v_and_b32 v6, 0x7ff, v6
    v_and_b32 v7, 0x7ff, v7
    v_cvt_f32_u32 v4, v4
    v_cvt_f32_u32 v5, v5
    v_cvt_f32_u32 v6, v6
    v_cvt_f32_u32 v7, v7
    v_mul_f32 v4, s42, v4
    v_mul_f32 v5, s42, v5
    v_mul_f32 v6, s42, v6
    v_mul_f32 v7, s42, v7
    v_cos_f32 v8, v4
    v_cos_f32 v9, v5
    v_cos_f32 v10, v6
    v_cos_f32 v11, v7
    v_sin_f32 v4, v4
    v_sin_f32 v5, v5
    v_sin_f32 v6, v6
    v_sin_f32 v7, v7
    v_cvt_pk_bf16_f32 v8, v8, v4
    v_cvt_pk_bf16_f32 v9, v9, v5
    v_cvt_pk_bf16_f32 v10, v10, v6
    v_cvt_pk_bf16_f32 v11, v11, v7
    v_xor_b32 v132, s38, v8
    v_xor_b32 v133, s38, v9
    v_xor_b32 v134, s38, v10
    v_xor_b32 v135, s38, v11
    v_mad_u32_u24 v4, v90, 16, v91
    v_mad_u32_u24 v5, v90, 17, v91
    v_mad_u32_u24 v6, v90, 18, v91
    v_mad_u32_u24 v7, v90, 19, v91
    v_and_b32 v4, 0x7ff, v4
    v_and_b32 v5, 0x7ff, v5
    v_and_b32 v6, 0x7ff, v6
    v_and_b32 v7, 0x7ff, v7
    v_cvt_f32_u32 v4, v4
    v_cvt_f32_u32 v5, v5
    v_cvt_f32_u32 v6, v6
    v_cvt_f32_u32 v7, v7
    v_mul_f32 v4, s42, v4
    v_mul_f32 v5, s42, v5
    v_mul_f32 v6, s42, v6
    v_mul_f32 v7, s42, v7
    v_cos_f32 v8, v4
    v_cos_f32 v9, v5
    v_cos_f32 v10, v6
    v_cos_f32 v11, v7
    v_sin_f32 v4, v4
    v_sin_f32 v5, v5
    v_sin_f32 v6, v6
    v_sin_f32 v7, v7
    v_cvt_pk_bf16_f32 v8, v8, v4
    v_cvt_pk_bf16_f32 v9, v9, v5
    v_cvt_pk_bf16_f32 v10, v10, v6
    v_cvt_pk_bf16_f32 v11, v11, v7
    v_xor_b32 v136, s38, v8
    v_xor_b32 v137, s38, v9
    v_xor_b32 v138, s38, v10
    v_xor_b32 v139, s38, v11
    v_mad_u32_u24 v4, v90, 24, v91
    v_mad_u32_u24 v5, v90, 25, v91
    v_mad_u32_u24 v6, v90, 26, v91
    v_mad_u32_u24 v7, v90, 27, v91
    v_and_b32 v4, 0x7ff, v4
    v_and_b32 v5, 0x7ff, v5
    v_and_b32 v6, 0x7ff, v6
    v_and_b32 v7, 0x7ff, v7
    v_cvt_f32_u32 v4, v4
    v_cvt_f32_u32 v5, v5
    v_cvt_f32_u32 v6, v6
    v_cvt_f32_u32 v7, v7
    v_mul_f32 v4, s42, v4
    v_mul_f32 v5, s42, v5
    v_mul_f32 v6, s42, v6
    v_mul_f32 v7, s42, v7
    v_cos_f32 v8, v4
    v_cos_f32 v9, v5
    v_cos_f32 v10, v6
    v_cos_f32 v11, v7
    v_sin_f32 v4, v4
    v_sin_f32 v5, v5
    v_sin_f32 v6, v6
    v_sin_f32 v7, v7
    v_cvt_pk_bf16_f32 v8, v8, v4
    v_cvt_pk_bf16_f32 v9, v9, v5
    v_cvt_pk_bf16_f32 v10, v10, v6
    v_cvt_pk_bf16_f32 v11, v11, v7
    v_xor_b32 v140, s38, v8
    v_xor_b32 v141, s38, v9
    v_xor_b32 v142, s38, v10
    v_xor_b32 v143, s38, v11
    v_mad_u32_u24 v4, v90, 32, v91
    v_mad_u32_u24 v5, v90, 33, v91
    v_mad_u32_u24 v6, v90, 34, v91
    v_mad_u32_u24 v7, v90, 35, v91
    v_and_b32 v4, 0x7ff, v4
    v_and_b32 v5, 0x7ff, v5
    v_and_b32 v6, 0x7ff, v6
    v_and_b32 v7, 0x7ff, v7
    v_cvt_f32_u32 v4, v4
    v_cvt_f32_u32 v5, v5
    v_cvt_f32_u32 v6, v6
    v_cvt_f32_u32 v7, v7
    v_mul_f32 v4, s42, v4
    v_mul_f32 v5, s42, v5
    v_mul_f32 v6, s42, v6
    v_mul_f32 v7, s42, v7
    v_cos_f32 v8, v4
    v_cos_f32 v9, v5
    v_cos_f32 v10, v6
    v_cos_f32 v11, v7
    v_sin_f32 v4, v4
    v_sin_f32 v5, v5
    v_sin_f32 v6, v6
    v_sin_f32 v7, v7
    v_cvt_pk_bf16_f32 v8, v8, v4
    v_cvt_pk_bf16_f32 v9, v9, v5
    v_cvt_pk_bf16_f32 v10, v10, v6
    v_cvt_pk_bf16_f32 v11, v11, v7
    v_xor_b32 v144, s38, v8
    v_xor_b32 v145, s38, v9
    v_xor_b32 v146, s38, v10
    v_xor_b32 v147, s38, v11
    v_mad_u32_u24 v4, v90, 40, v91
    v_mad_u32_u24 v5, v90, 41, v91
    v_mad_u32_u24 v6, v90, 42, v91
    v_mad_u32_u24 v7, v90, 43, v91
    v_and_b32 v4, 0x7ff, v4
    v_and_b32 v5, 0x7ff, v5
    v_and_b32 v6, 0x7ff, v6
    v_and_b32 v7, 0x7ff, v7
    v_cvt_f32_u32 v4, v4
    v_cvt_f32_u32 v5, v5
    v_cvt_f32_u32 v6, v6
    v_cvt_f32_u32 v7, v7
    v_mul_f32 v4, s42, v4
    v_mul_f32 v5, s42, v5
    v_mul_f32 v6, s42, v6
    v_mul_f32 v7, s42, v7
    v_cos_f32 v8, v4
    v_cos_f32 v9, v5
    v_cos_f32 v10, v6
    v_cos_f32 v11, v7
    v_sin_f32 v4, v4
    v_sin_f32 v5, v5
    v_sin_f32 v6, v6
    v_sin_f32 v7, v7
    v_cvt_pk_bf16_f32 v8, v8, v4
    v_cvt_pk_bf16_f32 v9, v9, v5
    v_cvt_pk_bf16_f32 v10, v10, v6
    v_cvt_pk_bf16_f32 v11, v11, v7
    v_xor_b32 v148, s38, v8
    v_xor_b32 v149, s38, v9
    v_xor_b32 v150, s38, v10
    v_xor_b32 v151, s38, v11
    v_mad_u32_u24 v4, v90, 48, v91
    v_mad_u32_u24 v5, v90, 49, v91
    v_mad_u32_u24 v6, v90, 50, v91
    v_mad_u32_u24 v7, v90, 51, v91
    v_and_b32 v4, 0x7ff, v4
    v_and_b32 v5, 0x7ff, v5
    v_and_b32 v6, 0x7ff, v6
    v_and_b32 v7, 0x7ff, v7
    v_cvt_f32_u32 v4, v4
    v_cvt_f32_u32 v5, v5
    v_cvt_f32_u32 v6, v6
    v_cvt_f32_u32 v7, v7
    v_mul_f32 v4, s42, v4
    v_mul_f32 v5, s42, v5
    v_mul_f32 v6, s42, v6
    v_mul_f32 v7, s42, v7
    v_cos_f32 v8, v4
    v_cos_f32 v9, v5
    v_cos_f32 v10, v6
    v_cos_f32 v11, v7
    v_sin_f32 v4, v4
    v_sin_f32 v5, v5
    v_sin_f32 v6, v6
    v_sin_f32 v7, v7
    v_cvt_pk_bf16_f32 v8, v8, v4
    v_cvt_pk_bf16_f32 v9, v9, v5
    v_cvt_pk_bf16_f32 v10, v10, v6
    v_cvt_pk_bf16_f32 v11, v11, v7
    v_xor_b32 v152, s38, v8
    v_xor_b32 v153, s38, v9
    v_xor_b32 v154, s38, v10
    v_xor_b32 v155, s38, v11
    v_mad_u32_u24 v4, v90, 56, v91
    v_mad_u32_u24 v5, v90, 57, v91
    v_mad_u32_u24 v6, v90, 58, v91
    v_mad_u32_u24 v7, v90, 59, v91
    v_and_b32 v4, 0x7ff, v4
    v_and_b32 v5, 0x7ff, v5
    v_and_b32 v6, 0x7ff, v6
    v_and_b32 v7, 0x7ff, v7
    v_cvt_f32_u32 v4, v4
    v_cvt_f32_u32 v5, v5
    v_cvt_f32_u32 v6, v6
    v_cvt_f32_u32 v7, v7
    v_mul_f32 v4, s42, v4
    v_mul_f32 v5, s42, v5
    v_mul_f32 v6, s42, v6
    v_mul_f32 v7, s42, v7
    v_cos_f32 v8, v4
    v_cos_f32 v9, v5
    v_cos_f32 v10, v6
    v_cos_f32 v11, v7
    v_sin_f32 v4, v4
    v_sin_f32 v5, v5
    v_sin_f32 v6, v6
    v_sin_f32 v7, v7
    v_cvt_pk_bf16_f32 v8, v8, v4
    v_cvt_pk_bf16_f32 v9, v9, v5
    v_cvt_pk_bf16_f32 v10, v10, v6
    v_cvt_pk_bf16_f32 v11, v11, v7
    v_xor_b32 v156, s38, v8
    v_xor_b32 v157, s38, v9
    v_xor_b32 v158, s38, v10
    v_xor_b32 v159, s38, v11
    s_lshl_b32 s52, s41, 7
    s_add_u32 s52, s52, s20
    s_add_u32 m0, s22, 16384
    s_mul_i32 s53, s41, 176128
    buffer_load_dwordx4 v100, s[24:27], s52 offen offset:0 lds
    buffer_load_dwordx4 v101, s[24:27], s52 offen offset:1024 lds
    buffer_load_dwordx4 v102, s[24:27], s52 offen offset:2048 lds
    buffer_load_dwordx4 v103, s[24:27], s52 offen offset:3072 lds
    s_add_u32 s53, s53, s36
    s_add_u32 m0, s37, 32768
    s_nop 0
    buffer_load_dwordx4 v104, s[28:31], s53 offen offset:0 lds
    buffer_load_dwordx4 v105, s[28:31], s53 offen offset:1024 lds
    buffer_load_dwordx4 v106, s[28:31], s53 offen offset:2048 lds
    buffer_load_dwordx4 v107, s[28:31], s53 offen offset:3072 lds
    s_add_u32 m0, s37, 36864
    s_nop 0
    buffer_load_dwordx4 v108, s[28:31], s53 offen offset:0 lds
    buffer_load_dwordx4 v109, s[28:31], s53 offen offset:1024 lds
    buffer_load_dwordx4 v110, s[28:31], s53 offen offset:2048 lds
    s_add_u32 s41, s41, 1
    s_and_b32 s41, s41, 7
    s_waitcnt vmcnt(11)
    s_barrier
    v_and_b32 v94, 3, v200
    v_lshlrev_b32 v94, 4, v94
    v_add_u32 v93, 161536, v94
    ds_read_b128 v[84:87], v93
    s_waitcnt lgkmcnt(0)
    s_cmp_eq_u32 s3, 4
    s_cbranch_scc0 lm_nr
    s_and_b32 s21, s2, 63
    s_lshl_b32 s21, s21, 8
    s_and_b32 s23, s2, 0xc0
    s_add_u32 s21, s21, s23
    s_add_u32 s21, s21, 0x900000
    s_mov_b64 exec, 15
    buffer_store_dwordx4 v[84:87], v94, s[56:59], s21 offen sc1
    s_mov_b64 exec, -1
lm_nr:
    s_cmp_eq_u32 s48, 0
    s_cbranch_scc0 lm_nc0
    ds_read_b64_tr_b16 v[64:65], v112 offset:0
    ds_read_b64_tr_b16 v[66:67], v112 offset:896
    ds_read_b64_tr_b16 v[68:69], v112 offset:3584
    ds_read_b64_tr_b16 v[70:71], v112 offset:4480
    ds_read_b64_tr_b16 v[72:73], v112 offset:128
    ds_read_b64_tr_b16 v[74:75], v112 offset:1024
    ds_read_b64_tr_b16 v[76:77], v112 offset:3712
    ds_read_b64_tr_b16 v[78:79], v112 offset:4608
    v_mov_b32 v80, 0
    v_mov_b32 v81, 0
    s_waitcnt lgkmcnt(0)
    v_dot2c_f32_bf16 v80, s43, v64
    v_dot2c_f32_bf16 v81, s43, v72
    v_dot2c_f32_bf16 v80, s43, v65
    v_dot2c_f32_bf16 v81, s43, v73
    v_dot2c_f32_bf16 v80, s43, v66
    v_dot2c_f32_bf16 v81, s43, v74
    v_dot2c_f32_bf16 v80, s43, v67
    v_dot2c_f32_bf16 v81, s43, v75
    v_dot2c_f32_bf16 v80, s43, v68
    v_dot2c_f32_bf16 v81, s43, v76
    v_dot2c_f32_bf16 v80, s43, v69
    v_dot2c_f32_bf16 v81, s43, v77
    v_dot2c_f32_bf16 v80, s43, v70
    v_dot2c_f32_bf16 v81, s43, v78
    v_dot2c_f32_bf16 v80, s43, v71
    v_dot2c_f32_bf16 v81, s43, v79
    s_nop 2
    v_mov_b32 v82, v80
    v_mov_b32 v83, v81
    s_nop 1
    v_permlane32_swap_b32 v80, v82
    v_permlane32_swap_b32 v81, v83
    s_nop 1
    v_add_f32 v80, v80, v82
    v_add_f32 v81, v81, v83
    s_mov_b32 exec_hi, 0
    buffer_store_dword v80, v97, s[56:59], s39 offen offset:0 sc1
    buffer_store_dword v81, v97, s[56:59], s39 offen offset:512 sc1
    s_mov_b32 exec_hi, -1
lm_nc0:
    buffer_load_dwordx2 v[88:89], v98, s[60:63], 0 offen sc1
    s_lshl_b32 s52, s41, 7
    s_add_u32 s52, s52, s20
    s_add_u32 m0, s22, 32768
    s_mul_i32 s53, s41, 176128
    buffer_load_dwordx4 v100, s[24:27], s52 offen offset:0 lds
    buffer_load_dwordx4 v101, s[24:27], s52 offen offset:1024 lds
    buffer_load_dwordx4 v102, s[24:27], s52 offen offset:2048 lds
    buffer_load_dwordx4 v103, s[24:27], s52 offen offset:3072 lds
    s_add_u32 s53, s53, s36
    s_add_u32 m0, s37, 65536
    s_nop 0
    buffer_load_dwordx4 v104, s[28:31], s53 offen offset:0 lds
    buffer_load_dwordx4 v105, s[28:31], s53 offen offset:1024 lds
    buffer_load_dwordx4 v106, s[28:31], s53 offen offset:2048 lds
    buffer_load_dwordx4 v107, s[28:31], s53 offen offset:3072 lds
    s_add_u32 m0, s37, 69632
    s_nop 0
    buffer_load_dwordx4 v108, s[28:31], s53 offen offset:0 lds
    buffer_load_dwordx4 v109, s[28:31], s53 offen offset:1024 lds
    buffer_load_dwordx4 v110, s[28:31], s53 offen offset:2048 lds
    s_add_u32 s41, s41, 1
    s_and_b32 s41, s41, 7
    s_waitcnt vmcnt(12)
    s_barrier
    s_cmp_eq_u32 s48, 1
    s_cbranch_scc0 lm_nc1
    ds_read_b64_tr_b16 v[64:65], v112 offset:32768
    ds_read_b64_tr_b16 v[66:67], v112 offset:33664
    ds_read_b64_tr_b16 v[68:69], v112 offset:36352
    ds_read_b64_tr_b16 v[70:71], v112 offset:37248
    ds_read_b64_tr_b16 v[72:73], v112 offset:32896
    ds_read_b64_tr_b16 v[74:75], v112 offset:33792
    ds_read_b64_tr_b16 v[76:77], v112 offset:36480
    ds_read_b64_tr_b16 v[78:79], v112 offset:37376
    v_mov_b32 v80, 0
    v_mov_b32 v81, 0
    s_waitcnt lgkmcnt(0)
    v_dot2c_f32_bf16 v80, s43, v64
    v_dot2c_f32_bf16 v81, s43, v72
    v_dot2c_f32_bf16 v80, s43, v65
    v_dot2c_f32_bf16 v81, s43, v73
    v_dot2c_f32_bf16 v80, s43, v66
    v_dot2c_f32_bf16 v81, s43, v74
    v_dot2c_f32_bf16 v80, s43, v67
    v_dot2c_f32_bf16 v81, s43, v75
    v_dot2c_f32_bf16 v80, s43, v68
    v_dot2c_f32_bf16 v81, s43, v76
    v_dot2c_f32_bf16 v80, s43, v69
    v_dot2c_f32_bf16 v81, s43, v77
    v_dot2c_f32_bf16 v80, s43, v70
    v_dot2c_f32_bf16 v81, s43, v78
    v_dot2c_f32_bf16 v80, s43, v71
    v_dot2c_f32_bf16 v81, s43, v79
    s_nop 2
    v_mov_b32 v82, v80
    v_mov_b32 v83, v81
    s_nop 1
    v_permlane32_swap_b32 v80, v82
    v_permlane32_swap_b32 v81, v83
    s_nop 1
    v_add_f32 v80, v80, v82
    v_add_f32 v81, v81, v83
    s_mov_b32 exec_hi, 0
    buffer_store_dword v80, v97, s[56:59], s39 offen offset:0 sc1
    buffer_store_dword v81, v97, s[56:59], s39 offen offset:512 sc1
    s_mov_b32 exec_hi, -1
lm_nc1:
    s_lshl_b32 s52, s41, 7
    s_add_u32 s52, s52, s20
    s_add_u32 m0, s22, 0
    s_mul_i32 s53, s41, 176128
    buffer_load_dwordx4 v100, s[24:27], s52 offen offset:0 lds
    buffer_load_dwordx4 v101, s[24:27], s52 offen offset:1024 lds
    buffer_load_dwordx4 v102, s[24:27], s52 offen offset:2048 lds
    buffer_load_dwordx4 v103, s[24:27], s52 offen offset:3072 lds
    s_add_u32 s53, s53, s36
    s_add_u32 m0, s37, 0
    s_nop 0
    buffer_load_dwordx4 v104, s[28:31], s53 offen offset:0 lds
    buffer_load_dwordx4 v105, s[28:31], s53 offen offset:1024 lds
    buffer_load_dwordx4 v106, s[28:31], s53 offen offset:2048 lds
    buffer_load_dwordx4 v107, s[28:31], s53 offen offset:3072 lds
    s_add_u32 m0, s37, 4096
    s_nop 0
    buffer_load_dwordx4 v108, s[28:31], s53 offen offset:0 lds
    buffer_load_dwordx4 v109, s[28:31], s53 offen offset:1024 lds
    buffer_load_dwordx4 v110, s[28:31], s53 offen offset:2048 lds
    s_add_u32 s41, s41, 1
    s_and_b32 s41, s41, 7
    s_waitcnt vmcnt(11)
    s_barrier
    s_waitcnt vmcnt(11)
    s_mov_b32 s21, 0
lm_tp:
    v_cmp_eq_u32 vcc, 0, v89
    s_add_u32 s21, s21, 1
    s_nop 3
    s_cbranch_vccz lm_tk
    s_cmp_lt_u32 s21, 65536
    s_cbranch_scc0 lm_tk
    s_sleep 2
    buffer_load_dwordx2 v[88:89], v98, s[60:63], 0 offen sc1
    s_waitcnt vmcnt(0)
    s_branch lm_tp
lm_tk:
    s_cmp_eq_u32 s3, 4
    s_cbranch_scc0 lm_na
    s_lshl_b32 s21, s16, 4
    s_add_u32 s21, s21, s17
    s_add_u32 s23, s2, 256
    v_mov_b32 v93, s21
    v_writelane_b32 v93, s23, 1
    s_mov_b32 s21, 0x990000
    v_lshlrev_b32 v93, 7, v93
    v_mov_b32 v92, 161600
    s_mov_b64 exec, 3
    buffer_store_dwordx2 v[88:89], v93, s[56:59], s21 offen sc1
    ds_write_b64 v92, v[88:89]
    s_mov_b64 exec, -1
lm_na:
    s_lshl_b32 s52, s41, 7
    s_add_u32 s52, s52, s20
    s_add_u32 m0, s22, 16384
    s_mul_i32 s53, s41, 176128
    buffer_load_dwordx4 v100, s[24:27], s52 offen offset:0 lds
    buffer_load_dwordx4 v101, s[24:27], s52 offen offset:1024 lds
    buffer_load_dwordx4 v102, s[24:27], s52 offen offset:2048 lds
    buffer_load_dwordx4 v103, s[24:27], s52 offen offset:3072 lds
    s_add_u32 s53, s53, s36
    s_add_u32 m0, s37, 32768
    s_nop 0
    buffer_load_dwordx4 v104, s[28:31], s53 offen offset:0 lds
    buffer_load_dwordx4 v105, s[28:31], s53 offen offset:1024 lds
    buffer_load_dwordx4 v106, s[28:31], s53 offen offset:2048 lds
    buffer_load_dwordx4 v107, s[28:31], s53 offen offset:3072 lds
    s_add_u32 m0, s37, 36864
    s_nop 0
    buffer_load_dwordx4 v108, s[28:31], s53 offen offset:0 lds
    buffer_load_dwordx4 v109, s[28:31], s53 offen offset:1024 lds
    buffer_load_dwordx4 v110, s[28:31], s53 offen offset:2048 lds
    s_add_u32 s41, s41, 1
    s_and_b32 s41, s41, 7
    s_lshl2_add_u32 s21, s2, s18
    s_mul_i32 s21, s21, 1408
    v_min_u32 v254, 10, v200
    v_lshlrev_b32 v254, 7, v254
    buffer_load_dword v255, v254, s[32:35], s21 offen
    s_waitcnt vmcnt(12)
    s_barrier
    s_lshl_b32 s52, s41, 7
    s_add_u32 s52, s52, s20
    s_add_u32 m0, s22, 32768
    s_mul_i32 s53, s41, 176128
    buffer_load_dwordx4 v100, s[24:27], s52 offen offset:0 lds
    buffer_load_dwordx4 v101, s[24:27], s52 offen offset:1024 lds
    buffer_load_dwordx4 v102, s[24:27], s52 offen offset:2048 lds
    buffer_load_dwordx4 v103, s[24:27], s52 offen offset:3072 lds
    s_add_u32 s53, s53, s36
    s_add_u32 m0, s37, 65536
    s_nop 0
    buffer_load_dwordx4 v104, s[28:31], s53 offen offset:0 lds
    buffer_load_dwordx4 v105, s[28:31], s53 offen offset:1024 lds
    buffer_load_dwordx4 v106, s[28:31], s53 offen offset:2048 lds
    buffer_load_dwordx4 v107, s[28:31], s53 offen offset:3072 lds
    s_add_u32 m0, s37, 69632
    s_nop 0
    buffer_load_dwordx4 v108, s[28:31], s53 offen offset:0 lds
    buffer_load_dwordx4 v109, s[28:31], s53 offen offset:1024 lds
    buffer_load_dwordx4 v110, s[28:31], s53 offen offset:2048 lds
    s_add_u32 s41, s41, 1
    s_and_b32 s41, s41, 7
    s_waitcnt vmcnt(12)
    s_barrier
    v_and_b32 v94, 15, v200
    v_lshl_add_u32 v95, v94, 4, s17
    v_lshrrev_b32 v93, 2, v94
    v_lshlrev_b32 v93, 6, v93
    v_and_b32 v92, 2, v94
    v_and_b32 v94, 1, v94
    v_lshl_add_u32 v94, v92, 4, v94
    s_lshl_b32 s21, s16, 1
    s_add_u32 s21, s21, 256
    v_add3_u32 v93, v93, v94, s21
    v_and_b32 v92, 16, v200
    v_cmp_eq_u32 vcc, 0, v92
    s_mov_b32 s55, 0x990000
    s_nop 0
    v_cndmask_b32 v95, v93, v95, vcc
    v_lshlrev_b32 v95, 7, v95
    s_lshl_b32 s21, s18, 3
    s_lshl_b64 s[50:51], 0xff, s21
    s_mov_b64 exec, s[50:51]
    buffer_load_dwordx2 v[86:87], v95, s[56:59], s55 offen sc1
    s_mov_b64 exec, -1
    s_lshl_b32 s52, s41, 7
    s_add_u32 s52, s52, s20
    s_add_u32 m0, s22, 0
    s_mul_i32 s53, s41, 176128
    buffer_load_dwordx4 v100, s[24:27], s52 offen offset:0 lds
    buffer_load_dwordx4 v101, s[24:27], s52 offen offset:1024 lds
    buffer_load_dwordx4 v102, s[24:27], s52 offen offset:2048 lds
    buffer_load_dwordx4 v103, s[24:27], s52 offen offset:3072 lds
    s_add_u32 s53, s53, s36
    s_add_u32 m0, s37, 0
    s_nop 0
    buffer_load_dwordx4 v104, s[28:31], s53 offen offset:0 lds
    buffer_load_dwordx4 v105, s[28:31], s53 offen offset:1024 lds
    buffer_load_dwordx4 v106, s[28:31], s53 offen offset:2048 lds
    buffer_load_dwordx4 v107, s[28:31], s53 offen offset:3072 lds
    s_add_u32 m0, s37, 4096
    s_nop 0
    buffer_load_dwordx4 v108, s[28:31], s53 offen offset:0 lds
    buffer_load_dwordx4 v109, s[28:31], s53 offen offset:1024 lds
    buffer_load_dwordx4 v110, s[28:31], s53 offen offset:2048 lds
    s_add_u32 s41, s41, 1
    s_and_b32 s41, s41, 7
    s_lshl_b32 s21, s17, 14
    s_lshl_b32 s23, s18, 8
    s_add_u32 s21, s21, s23
    s_add_u32 s100, s21, 0x910000
    v_and_b32 v92, 15, v200
    v_lshrrev_b32 v93, 4, v200
    v_lshlrev_b32 v92, 4, v92
    v_lshl_add_u32 v84, v93, 10, v92
    s_and_b32 s23, s18, 1
    s_lshl_b32 s21, s16, 9
    s_lshl_b32 s23, s23, 8
    v_and_b32 v93, 1, v200
    v_lshrrev_b32 v94, 1, v200
    v_lshlrev_b32 v94, 3, v94
    v_lshl_add_u32 v94, v93, 13, v94
    s_add_u32 s21, s21, s23
    s_add_u32 s101, s21, 0x900000
    v_mov_b32 v83, 161616
    v_mov_b32 v82, 1
    v_mov_b32 v226, v88
    v_mov_b32 v227, v89
    s_waitcnt vmcnt(12)
    s_barrier
    s_waitcnt vmcnt(11)
    s_mov_b32 s21, 0
    s_mov_b64 exec, s[50:51]
lm_sp:
    v_cmp_ne_u64 vcc, v[88:89], v[86:87]
    s_add_u32 s21, s21, 1
    s_nop 3
    s_cbranch_vccz lm_ok
    s_cmp_lt_u32 s21, 65536
    s_cbranch_scc0 lm_ok
    s_sleep 2
    buffer_load_dwordx2 v[86:87], v95, s[56:59], s55 offen sc1
    s_waitcnt vmcnt(0)
    s_branch lm_sp
lm_ok:
    s_mov_b64 exec, 1
    ds_add_u32 v83, v82
    s_mov_b32 s21, 0
lm_lw:
    ds_read_b32 v82, v83
    s_add_u32 s21, s21, 1
    s_waitcnt lgkmcnt(0)
    v_cmp_ne_u32 vcc, 4, v82
    s_cmp_lt_u32 s21, 1048576
    s_nop 2
    s_cbranch_vccz lm_lx
    s_cbranch_scc1 lm_lw
lm_lx:
    s_mov_b64 exec, -1
    buffer_load_dwordx4 v[64:67], v84, s[56:59], s100 offen sc1
    s_add_u32 s100, s100, 4096
    buffer_load_dwordx4 v[68:71], v84, s[56:59], s100 offen sc1
    s_add_u32 s100, s100, 4096
    buffer_load_dwordx4 v[72:75], v84, s[56:59], s100 offen sc1
    s_add_u32 s100, s100, 4096
    buffer_load_dwordx4 v[76:79], v84, s[56:59], s100 offen sc1
    buffer_load_dwordx2 v[80:81], v94, s[56:59], s101 offen sc1
    s_lshl_b32 s52, s41, 7
    s_add_u32 s52, s52, s20
    s_add_u32 m0, s22, 16384
    s_mul_i32 s53, s41, 176128
    buffer_load_dwordx4 v100, s[24:27], s52 offen offset:0 lds
    buffer_load_dwordx4 v101, s[24:27], s52 offen offset:1024 lds
    buffer_load_dwordx4 v102, s[24:27], s52 offen offset:2048 lds
    buffer_load_dwordx4 v103, s[24:27], s52 offen offset:3072 lds
    s_add_u32 s53, s53, s36
    s_add_u32 m0, s37, 32768
    s_nop 0
    buffer_load_dwordx4 v104, s[28:31], s53 offen offset:0 lds
    buffer_load_dwordx4 v105, s[28:31], s53 offen offset:1024 lds
    buffer_load_dwordx4 v106, s[28:31], s53 offen offset:2048 lds
    buffer_load_dwordx4 v107, s[28:31], s53 offen offset:3072 lds
    s_add_u32 m0, s37, 36864
    s_nop 0
    buffer_load_dwordx4 v108, s[28:31], s53 offen offset:0 lds
    buffer_load_dwordx4 v109, s[28:31], s53 offen offset:1024 lds
    buffer_load_dwordx4 v110, s[28:31], s53 offen offset:2048 lds
    s_add_u32 s41, s41, 1
    s_and_b32 s41, s41, 7
    s_waitcnt vmcnt(16)
    s_barrier
    s_lshl_b32 s75, s18, 14
    s_lshl_b32 s21, s71, 7
    s_add_u32 s75, s75, s21
    s_lshl_b32 s22, s18, 11
    s_waitcnt vmcnt(11)
    v_pk_add_f32 v[64:65], v[64:65], v[72:73]
    v_pk_add_f32 v[66:67], v[66:67], v[74:75]
    v_pk_add_f32 v[68:69], v[68:69], v[76:77]
    v_pk_add_f32 v[70:71], v[70:71], v[78:79]
    v_pk_add_f32 v[64:65], v[64:65], v[68:69]
    v_pk_add_f32 v[66:67], v[66:67], v[70:71]
    v_mov_b32 v68, v64
    v_mov_b32 v69, v65
    v_mov_b32 v70, v66
    v_mov_b32 v71, v67
    s_nop 1
    v_permlane16_swap_b32 v64, v68
    v_permlane16_swap_b32 v65, v69
    v_permlane16_swap_b32 v66, v70
    v_permlane16_swap_b32 v67, v71
    s_nop 1
    v_pk_add_f32 v[64:65], v[64:65], v[68:69]
    v_pk_add_f32 v[66:67], v[66:67], v[70:71]
    v_mov_b32 v68, v64
    v_mov_b32 v69, v65
    v_mov_b32 v70, v66
    v_mov_b32 v71, v67
    s_nop 1
    v_permlane32_swap_b32 v64, v68
    v_permlane32_swap_b32 v65, v69
    v_permlane32_swap_b32 v66, v70
    v_permlane32_swap_b32 v67, v71
    s_nop 1
    v_pk_add_f32 v[64:65], v[64:65], v[68:69]
    v_pk_add_f32 v[66:67], v[66:67], v[70:71]
    s_lshl_b32 s21, s18, 8
    s_add_u32 s21, s21, 162816
    v_add_u32 v94, s21, v92
    ds_write_b128 v94, v[64:67]
    s_and_b32 s21, s18, 1
    s_lshl_b32 s21, s21, 8
    s_add_u32 s21, s21, 161792
    v_add_u32 v94, s21, v97
    ds_write_b32 v94, v80
    ds_write_b32 v94, v81 offset:512
    s_waitcnt lgkmcnt(0)
    s_waitcnt vmcnt(0)
    s_barrier
    s_lshl_b32 s53, s74, 16
    s_add_u32 s53, s53, s75
    s_add_u32 m0, s22, 32768
    s_add_u32 s74, s74, 1
    s_cmp_eq_u32 s74, 22
    s_cselect_b32 s74, 0, s74
    buffer_load_dwordx4 v220, s[32:35], s53 offen offset:0 lds
    buffer_load_dwordx4 v221, s[32:35], s53 offen offset:1024 lds
    s_waitcnt vmcnt(6)
    s_lshl_b32 s53, s74, 16
    s_add_u32 s53, s53, s75
    s_add_u32 m0, s22, 40960
    s_add_u32 s74, s74, 1
    s_cmp_eq_u32 s74, 22
    s_cselect_b32 s74, 0, s74
    buffer_load_dwordx4 v220, s[32:35], s53 offen offset:0 lds
    buffer_load_dwordx4 v221, s[32:35], s53 offen offset:1024 lds
    s_waitcnt vmcnt(6)
    s_lshl_b32 s53, s74, 16
    s_add_u32 s53, s53, s75
    s_add_u32 m0, s22, 114688
    s_add_u32 s74, s74, 1
    s_cmp_eq_u32 s74, 22
    s_cselect_b32 s74, 0, s74
    buffer_load_dwordx4 v220, s[32:35], s53 offen offset:0 lds
    buffer_load_dwordx4 v221, s[32:35], s53 offen offset:1024 lds
    s_waitcnt vmcnt(6)
    s_lshl_b32 s53, s74, 16
    s_add_u32 s53, s53, s75
    s_add_u32 m0, s22, 122880
    s_add_u32 s74, s74, 1
    s_cmp_eq_u32 s74, 22
    s_cselect_b32 s74, 0, s74
    buffer_load_dwordx4 v220, s[32:35], s53 offen offset:0 lds
    buffer_load_dwordx4 v221, s[32:35], s53 offen offset:1024 lds
    s_waitcnt vmcnt(6)
    s_lshl_b32 s53, s74, 16
    s_add_u32 s53, s53, s75
    s_add_u32 m0, s22, 131072
    s_add_u32 s74, s74, 1
    s_cmp_eq_u32 s74, 22
    s_cselect_b32 s74, 0, s74
    buffer_load_dwordx4 v220, s[32:35], s53 offen offset:0 lds
    buffer_load_dwordx4 v221, s[32:35], s53 offen offset:1024 lds
    s_waitcnt vmcnt(6)
    s_lshl_b32 s53, s74, 16
    s_add_u32 s53, s53, s75
    s_add_u32 m0, s22, 139264
    s_add_u32 s74, s74, 1
    s_cmp_eq_u32 s74, 22
    s_cselect_b32 s74, 0, s74
    buffer_load_dwordx4 v220, s[32:35], s53 offen offset:0 lds
    buffer_load_dwordx4 v221, s[32:35], s53 offen offset:1024 lds
    s_waitcnt vmcnt(6)
    s_lshl_b32 s53, s74, 16
    s_add_u32 s53, s53, s75
    s_add_u32 m0, s22, 147456
    s_add_u32 s74, s74, 1
    s_cmp_eq_u32 s74, 22
    s_cselect_b32 s74, 0, s74
    buffer_load_dwordx4 v220, s[32:35], s53 offen offset:0 lds
    buffer_load_dwordx4 v221, s[32:35], s53 offen offset:1024 lds
    s_waitcnt vmcnt(6)
    s_lshl_b32 s53, s74, 16
    s_add_u32 s53, s53, s75
    s_add_u32 m0, s22, 0
    s_add_u32 s74, s74, 1
    s_cmp_eq_u32 s74, 22
    s_cselect_b32 s74, 0, s74
    buffer_load_dwordx4 v220, s[32:35], s53 offen offset:0 lds
    buffer_load_dwordx4 v221, s[32:35], s53 offen offset:1024 lds
    s_waitcnt vmcnt(6)
    s_lshl_b32 s53, s74, 16
    s_add_u32 s53, s53, s75
    s_add_u32 m0, s22, 8192
    s_add_u32 s74, s74, 1
    s_cmp_eq_u32 s74, 22
    s_cselect_b32 s74, 0, s74
    buffer_load_dwordx4 v220, s[32:35], s53 offen offset:0 lds
    buffer_load_dwordx4 v221, s[32:35], s53 offen offset:1024 lds
    s_waitcnt vmcnt(6)
    s_lshl_b32 s53, s74, 16
    s_add_u32 s53, s53, s75
    s_add_u32 m0, s22, 49152
    s_add_u32 s74, s74, 1
    s_cmp_eq_u32 s74, 22
    s_cselect_b32 s74, 0, s74
    buffer_load_dwordx4 v220, s[32:35], s53 offen offset:0 lds
    buffer_load_dwordx4 v221, s[32:35], s53 offen offset:1024 lds
    s_waitcnt vmcnt(6)
    s_lshl_b32 s53, s74, 16
    s_add_u32 s53, s53, s75
    s_add_u32 m0, s22, 57344
    s_add_u32 s74, s74, 1
    s_cmp_eq_u32 s74, 22
    s_cselect_b32 s74, 0, s74
    buffer_load_dwordx4 v220, s[32:35], s53 offen offset:0 lds
    buffer_load_dwordx4 v221, s[32:35], s53 offen offset:1024 lds
    s_waitcnt vmcnt(6)
    s_lshl_b32 s53, s74, 16
    s_add_u32 s53, s53, s75
    s_add_u32 m0, s22, 65536
    s_add_u32 s74, s74, 1
    s_cmp_eq_u32 s74, 22
    s_cselect_b32 s74, 0, s74
    buffer_load_dwordx4 v220, s[32:35], s53 offen offset:0 lds
    buffer_load_dwordx4 v221, s[32:35], s53 offen offset:1024 lds
    s_waitcnt vmcnt(6)
    s_lshl_b32 s53, s74, 16
    s_add_u32 s53, s53, s75
    s_add_u32 m0, s22, 73728
    s_add_u32 s74, s74, 1
    s_cmp_eq_u32 s74, 22
    s_cselect_b32 s74, 0, s74
    buffer_load_dwordx4 v220, s[32:35], s53 offen offset:0 lds
    buffer_load_dwordx4 v221, s[32:35], s53 offen offset:1024 lds
    s_waitcnt vmcnt(6)
    s_barrier
    s_branch p2_b
k_c:
    s_waitcnt lgkmcnt(0)
    s_mov_b64 s[6:7], s[70:71]
    s_getpc_b64 s[22:23]
k_pc:
    v_lshlrev_b32 v2, 7, v0
    s_sub_u32 s22, s22, k_pc-lm
    s_subb_u32 s23, s23, 0
    v_cmp_gt_u32 vcc, k_end-lm, v2
    v_mov_b32 v3, s23
    v_add_co_u32 v2, s[24:25], s22, v2
    s_nop 1
    v_addc_co_u32 v3, s[24:25], 0, v3, s[24:25]
    s_and_saveexec_b64 s[24:25], vcc
    s_cbranch_execz k_npf
    global_load_dword v255, v[2:3], off
k_npf:
    s_mov_b64 exec, s[24:25]
    s_and_b32 s52, s2, 7
    s_lshr_b32 s53, s2, 3
    s_and_b32 s70, s52, 7
    s_lshl_b32 s70, s70, 2
    s_and_b32 s23, s53, 3
    s_add_u32 s70, s70, s23
    s_lshr_b32 s71, s52, 3
    s_lshl_b32 s71, s71, 3
    s_lshr_b32 s23, s53, 2
    s_add_u32 s71, s71, s23
    s_mul_i32 s77, s71, 11
    s_mul_i32 s23, s70, 2
    s_add_u32 s77, s77, s23
    s_mul_i32 s23, s77, 2979
    s_lshr_b32 s23, s23, 16
    s_mul_i32 s23, s23, 22
    s_sub_u32 s77, s77, s23
    s_mov_b32 s74, s77
    s_and_b32 s72, s3, 1
    s_bfe_u32 s73, s3, 0x10001
    s_lshl_b32 s76, s73, 20
    s_lshl_b32 s23, s70, 10
    s_add_u32 s76, s76, s23
    s_lshl_b32 s23, s71, 7
    s_add_u32 s76, s76, s23
    s_lshl_b32 s23, s72, 6
    s_add_u32 s76, s76, s23
    s_cmp_ge_u32 s17, 13
    s_cbranch_scc1 cd
cm:
    v_lshlrev_b32 v204, 4, v200
    s_lshr_b32 s20, s2, 6
    s_lshl_b32 s20, s20, 2
    s_add_u32 s20, s20, s18
    s_lshl_b32 s20, s20, 17
    s_and_b32 s21, s2, 63
    s_lshl_b32 s21, s21, 10
    s_add_u32 s21, s21, s20
    s_add_u32 s22, s21, 65536
    s_mov_b32 s24, s4
    s_and_b32 s25, s5, 0xffff
    s_mov_b32 s26, 0x200000
    s_mov_b32 s27, 0x00020000
    buffer_load_dwordx4 v[112:115], v204, s[24:27], s21 offen
    buffer_load_dwordx4 v[116:119], v204, s[24:27], s22 offen
    s_mov_b32 s56, s6
    s_and_b32 s57, s7, 0xffff
    s_mov_b32 s58, 0x10000000
    s_mov_b32 s59, 0x00020000
    s_or_b32 s20, s2, s3
    s_cbranch_scc1 cm_nt
    s_mov_b32 s60, s68
    s_and_b32 s61, s69, 0xffff
    s_mov_b32 s62, 0x100
    s_mov_b32 s63, 0x00020000
    s_memrealtime s[20:21]
    s_waitcnt lgkmcnt(0)
    s_and_b32 s21, s21, 0x0fffffff
    s_or_b32 s21, s21, 0x80000000
    v_mov_b32 v124, s20
    v_mov_b32 v125, s21
    v_mov_b32 v126, 0
    s_mov_b64 exec, 1
    buffer_store_dwordx2 v[124:125], v126, s[60:63], 0 offen sc1
    s_mov_b64 exec, -1
cm_nt:
    v_and_b32 v204, 31, v200
    v_lshrrev_b32 v205, 5, v200
    v_bfe_u32 v206, v200, 1, 3
    v_xor_b32 v206, v206, v205
    s_lshl_b32 s21, s18, 12
    v_lshl_add_u32 v207, v204, 7, s21
    v_xor_b32 v208, 0, v206
    v_lshl_add_u32 v176, v208, 4, v207
    v_xor_b32 v208, 2, v206
    v_lshl_add_u32 v177, v208, 4, v207
    v_xor_b32 v208, 4, v206
    v_lshl_add_u32 v178, v208, 4, v207
    v_xor_b32 v208, 6, v206
    v_lshl_add_u32 v179, v208, 4, v207
    s_mov_b32 s23, 49152
    v_lshrrev_b32 v205, 5, v200
    v_bfe_u32 v206, v200, 2, 2
    v_lshl_add_u32 v206, v205, 3, v206
    v_mul_u32_u24 v206, 224, v206
    v_and_b32 v207, 3, v200
    v_lshl_add_u32 v206, v207, 3, v206
    v_bfe_u32 v207, v200, 4, 1
    v_mul_u32_u24 v207, 14464, v207
    v_add3_u32 v180, v206, v207, s23
    v_mov_b32 v0, 0
    v_mov_b32 v1, 0
    v_mov_b32 v2, 0
    v_mov_b32 v3, 0
    v_mov_b32 v4, 0
    v_mov_b32 v5, 0
    v_mov_b32 v6, 0
    v_mov_b32 v7, 0
    v_mov_b32 v8, 0
    v_mov_b32 v9, 0
    v_mov_b32 v10, 0
    v_mov_b32 v11, 0
    v_mov_b32 v12, 0
    v_mov_b32 v13, 0
    v_mov_b32 v14, 0
    v_mov_b32 v15, 0
    v_mov_b32 v16, 0
    v_mov_b32 v17, 0
    v_mov_b32 v18, 0
    v_mov_b32 v19, 0
    v_mov_b32 v20, 0
    v_mov_b32 v21, 0
    v_mov_b32 v22, 0
    v_mov_b32 v23, 0
    v_mov_b32 v24, 0
    v_mov_b32 v25, 0
    v_mov_b32 v26, 0
    v_mov_b32 v27, 0
    v_mov_b32 v28, 0
    v_mov_b32 v29, 0
    v_mov_b32 v30, 0
    v_mov_b32 v31, 0
    v_mov_b32 v32, 0
    v_mov_b32 v33, 0
    v_mov_b32 v34, 0
    v_mov_b32 v35, 0
    v_mov_b32 v36, 0
    v_mov_b32 v37, 0
    v_mov_b32 v38, 0
    v_mov_b32 v39, 0
    v_mov_b32 v40, 0
    v_mov_b32 v41, 0
    v_mov_b32 v42, 0
    v_mov_b32 v43, 0
    v_mov_b32 v44, 0
    v_mov_b32 v45, 0
    v_mov_b32 v46, 0
    v_mov_b32 v47, 0
    v_mov_b32 v48, 0
    v_mov_b32 v49, 0
    v_mov_b32 v50, 0
    v_mov_b32 v51, 0
    v_mov_b32 v52, 0
    v_mov_b32 v53, 0
    v_mov_b32 v54, 0
    v_mov_b32 v55, 0
    v_mov_b32 v56, 0
    v_mov_b32 v57, 0
    v_mov_b32 v58, 0
    v_mov_b32 v59, 0
    v_mov_b32 v60, 0
    v_mov_b32 v61, 0
    v_mov_b32 v62, 0
    v_mov_b32 v63, 0
    v_mov_b32 v64, 0
    v_mov_b32 v65, 0
    v_mov_b32 v66, 0
    v_mov_b32 v67, 0
    v_mov_b32 v68, 0
    v_mov_b32 v69, 0
    v_mov_b32 v70, 0
    v_mov_b32 v71, 0
    v_mov_b32 v72, 0
    v_mov_b32 v73, 0
    v_mov_b32 v74, 0
    v_mov_b32 v75, 0
    v_mov_b32 v76, 0
    v_mov_b32 v77, 0
    v_mov_b32 v78, 0
    v_mov_b32 v79, 0
    v_mov_b32 v80, 0
    v_mov_b32 v81, 0
    v_mov_b32 v82, 0
    v_mov_b32 v83, 0
    v_mov_b32 v84, 0
    v_mov_b32 v85, 0
    v_mov_b32 v86, 0
    v_mov_b32 v87, 0
    v_mov_b32 v88, 0
    v_mov_b32 v89, 0
    v_mov_b32 v90, 0
    v_mov_b32 v91, 0
    v_mov_b32 v92, 0
    v_mov_b32 v93, 0
    v_mov_b32 v94, 0
    v_mov_b32 v95, 0
    v_mov_b32 v96, 0
    v_mov_b32 v97, 0
    v_mov_b32 v98, 0
    v_mov_b32 v99, 0
    v_mov_b32 v100, 0
    v_mov_b32 v101, 0
    v_mov_b32 v102, 0
    v_mov_b32 v103, 0
    v_mov_b32 v104, 0
    v_mov_b32 v105, 0
    v_mov_b32 v106, 0
    v_mov_b32 v107, 0
    v_mov_b32 v108, 0
    v_mov_b32 v109, 0
    v_mov_b32 v110, 0
    v_mov_b32 v111, 0
    v_mov_b32 v144, 0
    v_mov_b32 v145, 0
    v_mov_b32 v146, 0
    v_mov_b32 v147, 0
    v_mov_b32 v148, 0
    v_mov_b32 v149, 0
    v_mov_b32 v150, 0
    v_mov_b32 v151, 0
    v_mov_b32 v152, 0
    v_mov_b32 v153, 0
    v_mov_b32 v154, 0
    v_mov_b32 v155, 0
    v_mov_b32 v156, 0
    v_mov_b32 v157, 0
    v_mov_b32 v158, 0
    v_mov_b32 v159, 0
    v_mov_b32 v160, 0
    v_mov_b32 v161, 0
    v_mov_b32 v162, 0
    v_mov_b32 v163, 0
    v_mov_b32 v164, 0
    v_mov_b32 v165, 0
    v_mov_b32 v166, 0
    v_mov_b32 v167, 0
    v_mov_b32 v168, 0
    v_mov_b32 v169, 0
    v_mov_b32 v170, 0
    v_mov_b32 v171, 0
    v_mov_b32 v172, 0
    v_mov_b32 v173, 0
    v_mov_b32 v174, 0
    v_mov_b32 v175, 0
    v_mov_b32 v120, 0
    v_mov_b32 v121, 0
    v_mov_b32 v122, 0
    v_mov_b32 v123, 0
    s_mov_b32 s31, 0x3f803f80
    s_waitcnt vmcnt(0)
    v_dot2c_f32_bf16 v120, v112, v112
    v_dot2c_f32_bf16 v121, s31, v112
    v_dot2c_f32_bf16 v122, v116, v116
    v_dot2c_f32_bf16 v123, s31, v116
    v_dot2c_f32_bf16 v120, v113, v113
    v_dot2c_f32_bf16 v121, s31, v113
    v_dot2c_f32_bf16 v122, v117, v117
    v_dot2c_f32_bf16 v123, s31, v117
    v_dot2c_f32_bf16 v120, v114, v114
    v_dot2c_f32_bf16 v121, s31, v114
    v_dot2c_f32_bf16 v122, v118, v118
    v_dot2c_f32_bf16 v123, s31, v118
    v_dot2c_f32_bf16 v120, v115, v115
    v_dot2c_f32_bf16 v121, s31, v115
    v_dot2c_f32_bf16 v122, v119, v119
    v_dot2c_f32_bf16 v123, s31, v119
    s_nop 2
    v_add_f32_dpp v120, v120, v120 row_shr:1 bound_ctrl:0
    v_add_f32_dpp v121, v121, v121 row_shr:1 bound_ctrl:0
    v_add_f32_dpp v122, v122, v122 row_shr:1 bound_ctrl:0
    v_add_f32_dpp v123, v123, v123 row_shr:1 bound_ctrl:0
    v_add_f32_dpp v120, v120, v120 row_shr:2 bound_ctrl:0
    v_add_f32_dpp v121, v121, v121 row_shr:2 bound_ctrl:0
    v_add_f32_dpp v122, v122, v122 row_shr:2 bound_ctrl:0
    v_add_f32_dpp v123, v123, v123 row_shr:2 bound_ctrl:0
    v_add_f32_dpp v120, v120, v120 row_shr:4 bound_ctrl:0
    v_add_f32_dpp v121, v121, v121 row_shr:4 bound_ctrl:0
    v_add_f32_dpp v122, v122, v122 row_shr:4 bound_ctrl:0
    v_add_f32_dpp v123, v123, v123 row_shr:4 bound_ctrl:0
    v_add_f32_dpp v120, v120, v120 row_shr:8 bound_ctrl:0
    v_add_f32_dpp v121, v121, v121 row_shr:8 bound_ctrl:0
    v_add_f32_dpp v122, v122, v122 row_shr:8 bound_ctrl:0
    v_add_f32_dpp v123, v123, v123 row_shr:8 bound_ctrl:0
    v_add_f32_dpp v120, v120, v120 row_bcast:15 row_mask:0xa
    v_add_f32_dpp v121, v121, v121 row_bcast:15 row_mask:0xa
    v_add_f32_dpp v122, v122, v122 row_bcast:15 row_mask:0xa
    v_add_f32_dpp v123, v123, v123 row_bcast:15 row_mask:0xa
    v_add_f32_dpp v120, v120, v120 row_bcast:31 row_mask:0xc
    v_add_f32_dpp v121, v121, v121 row_bcast:31 row_mask:0xc
    v_add_f32_dpp v122, v122, v122 row_bcast:31 row_mask:0xc
    v_add_f32_dpp v123, v123, v123 row_bcast:31 row_mask:0xc
    v_mov_b32 v128, 0x3b000000
    v_mul_f32 v124, v128, v121
    v_mul_f32 v129, v124, v124
    v_fma_f32 v125, v120, v128, -v129
    v_max_f32 v125, 0, v125
    v_add_f32 v125, 0x3727c5ac, v125
    v_mul_f32 v126, v128, v123
    v_mul_f32 v129, v126, v126
    v_fma_f32 v127, v122, v128, -v129
    v_max_f32 v127, 0, v127
    v_add_f32 v127, 0x3727c5ac, v127
    s_lshl_b32 s21, s18, 4
    s_add_u32 s21, s21, 161536
    v_mov_b32 v129, s21
    s_lshl_b64 exec, 1, 63
    ds_write_b128 v129, v[124:127]
    s_mov_b64 exec, -1
    s_mov_b32 s42, 0
    s_mov_b32 s43, 0
    s_mov_b32 s47, 16384
    s_lshl_b32 s53, s16, 1
    s_lshr_b32 s21, s18, 1
    s_add_u32 s53, s53, s21
    s_mul_i32 s53, s53, 86
    s_lshr_b32 s21, s19, 4
    s_add_u32 s53, s53, s21
    s_lshl_b32 s53, s53, 1
    s_and_b32 s21, s18, 1
    s_add_u32 s53, s53, s21
    s_lshl_b32 s53, s53, 10
    s_mov_b32 s60, s6
    s_and_b32 s61, s7, 0xffff
    s_mov_b32 s62, 0x10000000
    s_mov_b32 s63, 0x00020000
    s_cmp_eq_u32 s17, 12
    s_cselect_b32 s62, 0, s62
    s_lshl_b32 s55, s16, 4
    s_add_u32 s55, s55, s17
    s_lshl_b32 s55, s55, 7
    s_add_u32 s55, s55, 0x980000
    s_setprio 1
cm_loop:
    s_waitcnt lgkmcnt(0)
    s_barrier
    v_mfma_f32_32x32x16_bf16 v[0:15], v[148:151], v[144:147], v[0:15]
    ds_read_b128 v[112:115], v176
    ds_read_b64_tr_b16 v[116:117], v180 offset:0
    ds_read_b64_tr_b16 v[118:119], v180 offset:896
    v_mfma_f32_32x32x16_bf16 v[16:31], v[152:155], v[144:147], v[16:31]
    ds_read_b64_tr_b16 v[120:121], v180 offset:32
    ds_read_b64_tr_b16 v[122:123], v180 offset:928
    ds_read_b64_tr_b16 v[124:125], v180 offset:64
    v_mfma_f32_32x32x16_bf16 v[32:47], v[156:159], v[144:147], v[32:47]
    ds_read_b64_tr_b16 v[126:127], v180 offset:960
    ds_read_b64_tr_b16 v[128:129], v180 offset:96
    ds_read_b64_tr_b16 v[130:131], v180 offset:992
    v_mfma_f32_32x32x16_bf16 v[48:63], v[160:163], v[144:147], v[48:63]
    ds_read_b64_tr_b16 v[132:133], v180 offset:128
    ds_read_b64_tr_b16 v[134:135], v180 offset:1024
    ds_read_b64_tr_b16 v[136:137], v180 offset:160
    v_mfma_f32_32x32x16_bf16 v[64:79], v[164:167], v[144:147], v[64:79]
    ds_read_b64_tr_b16 v[138:139], v180 offset:1056
    ds_read_b64_tr_b16 v[140:141], v180 offset:192
    ds_read_b64_tr_b16 v[142:143], v180 offset:1088
    v_mfma_f32_32x32x16_bf16 v[80:95], v[168:171], v[144:147], v[80:95]
    v_mfma_f32_32x32x16_bf16 v[96:111], v[172:175], v[144:147], v[96:111]
    s_waitcnt lgkmcnt(0)
    v_mfma_f32_32x32x16_bf16 v[0:15], v[116:119], v[112:115], v[0:15]
    ds_read_b128 v[144:147], v177
    ds_read_b64_tr_b16 v[148:149], v180 offset:3584
    ds_read_b64_tr_b16 v[150:151], v180 offset:4480
    v_mfma_f32_32x32x16_bf16 v[16:31], v[120:123], v[112:115], v[16:31]
    ds_read_b64_tr_b16 v[152:153], v180 offset:3616
    ds_read_b64_tr_b16 v[154:155], v180 offset:4512
    ds_read_b64_tr_b16 v[156:157], v180 offset:3648
    v_mfma_f32_32x32x16_bf16 v[32:47], v[124:127], v[112:115], v[32:47]
    ds_read_b64_tr_b16 v[158:159], v180 offset:4544
    ds_read_b64_tr_b16 v[160:161], v180 offset:3680
    ds_read_b64_tr_b16 v[162:163], v180 offset:4576
    v_mfma_f32_32x32x16_bf16 v[48:63], v[128:131], v[112:115], v[48:63]
    ds_read_b64_tr_b16 v[164:165], v180 offset:3712
    ds_read_b64_tr_b16 v[166:167], v180 offset:4608
    ds_read_b64_tr_b16 v[168:169], v180 offset:3744
    v_mfma_f32_32x32x16_bf16 v[64:79], v[132:135], v[112:115], v[64:79]
    ds_read_b64_tr_b16 v[170:171], v180 offset:4640
    ds_read_b64_tr_b16 v[172:173], v180 offset:3776
    ds_read_b64_tr_b16 v[174:175], v180 offset:4672
    v_mfma_f32_32x32x16_bf16 v[80:95], v[136:139], v[112:115], v[80:95]
    v_mfma_f32_32x32x16_bf16 v[96:111], v[140:143], v[112:115], v[96:111]
    s_waitcnt lgkmcnt(0)
    v_mfma_f32_32x32x16_bf16 v[0:15], v[148:151], v[144:147], v[0:15]
    ds_read_b128 v[112:115], v178
    ds_read_b64_tr_b16 v[116:117], v180 offset:7168
    ds_read_b64_tr_b16 v[118:119], v180 offset:8064
    v_mfma_f32_32x32x16_bf16 v[16:31], v[152:155], v[144:147], v[16:31]
    ds_read_b64_tr_b16 v[120:121], v180 offset:7200
    ds_read_b64_tr_b16 v[122:123], v180 offset:8096
    ds_read_b64_tr_b16 v[124:125], v180 offset:7232
    v_mfma_f32_32x32x16_bf16 v[32:47], v[156:159], v[144:147], v[32:47]
    ds_read_b64_tr_b16 v[126:127], v180 offset:8128
    ds_read_b64_tr_b16 v[128:129], v180 offset:7264
    ds_read_b64_tr_b16 v[130:131], v180 offset:8160
    v_mfma_f32_32x32x16_bf16 v[48:63], v[160:163], v[144:147], v[48:63]
    ds_read_b64_tr_b16 v[132:133], v180 offset:7296
    ds_read_b64_tr_b16 v[134:135], v180 offset:8192
    ds_read_b64_tr_b16 v[136:137], v180 offset:7328
    v_mfma_f32_32x32x16_bf16 v[64:79], v[164:167], v[144:147], v[64:79]
    ds_read_b64_tr_b16 v[138:139], v180 offset:8224
    ds_read_b64_tr_b16 v[140:141], v180 offset:7360
    ds_read_b64_tr_b16 v[142:143], v180 offset:8256
    v_mfma_f32_32x32x16_bf16 v[80:95], v[168:171], v[144:147], v[80:95]
    v_mfma_f32_32x32x16_bf16 v[96:111], v[172:175], v[144:147], v[96:111]
    s_waitcnt lgkmcnt(0)
    v_mfma_f32_32x32x16_bf16 v[0:15], v[116:119], v[112:115], v[0:15]
    ds_read_b128 v[144:147], v179
    ds_read_b64_tr_b16 v[148:149], v180 offset:10752
    ds_read_b64_tr_b16 v[150:151], v180 offset:11648
    v_mfma_f32_32x32x16_bf16 v[16:31], v[120:123], v[112:115], v[16:31]
    ds_read_b64_tr_b16 v[152:153], v180 offset:10784
    ds_read_b64_tr_b16 v[154:155], v180 offset:11680
    ds_read_b64_tr_b16 v[156:157], v180 offset:10816
    v_mfma_f32_32x32x16_bf16 v[32:47], v[124:127], v[112:115], v[32:47]
    ds_read_b64_tr_b16 v[158:159], v180 offset:11712
    ds_read_b64_tr_b16 v[160:161], v180 offset:10848
    ds_read_b64_tr_b16 v[162:163], v180 offset:11744
    v_mfma_f32_32x32x16_bf16 v[48:63], v[128:131], v[112:115], v[48:63]
    ds_read_b64_tr_b16 v[164:165], v180 offset:10880
    ds_read_b64_tr_b16 v[166:167], v180 offset:11776
    ds_read_b64_tr_b16 v[168:169], v180 offset:10912
    v_mfma_f32_32x32x16_bf16 v[64:79], v[132:135], v[112:115], v[64:79]
    ds_read_b64_tr_b16 v[170:171], v180 offset:11808
    ds_read_b64_tr_b16 v[172:173], v180 offset:10944
    ds_read_b64_tr_b16 v[174:175], v180 offset:11840
    v_mfma_f32_32x32x16_bf16 v[80:95], v[136:139], v[112:115], v[80:95]
    s_add_u32 s43, s43, 1
    s_cmp_eq_u32 s43, 3
    s_cselect_b32 s45, -32768, s47
    s_cselect_b32 s43, 0, s43
    s_lshl_b32 s46, s45, 1
    v_mfma_f32_32x32x16_bf16 v[96:111], v[140:143], v[112:115], v[96:111]
    v_add_u32 v176, s45, v176
    v_add_u32 v177, s45, v177
    v_add_u32 v178, s45, v178
    v_add_u32 v179, s45, v179
    v_add_u32 v180, s46, v180
    s_add_u32 s42, s42, 1
    s_cmp_lt_u32 s42, 7
    s_cbranch_scc1 cm_loop
    s_waitcnt lgkmcnt(0)
    s_barrier
    s_lshl_b32 s21, s18, 7
    s_add_u32 s21, s21, 161792
    v_lshl_add_u32 v206, v204, 2, s21
    v_lshlrev_b32 v211, 2, v204
    v_add_u32 v211, 162816, v211
    v_mov_b32 v201, 161600
    v_mfma_f32_32x32x16_bf16 v[0:15], v[148:151], v[144:147], v[0:15]
    ds_read_b32 v207, v206
    ds_read_b32 v210, v206 offset:512
    ds_read_b64 v[202:203], v201
    ds_read_b32 v226, v211 offset:0
    ds_read_b32 v230, v211 offset:128
    ds_read_b32 v234, v211 offset:256
    v_mfma_f32_32x32x16_bf16 v[16:31], v[152:155], v[144:147], v[16:31]
    ds_read_b32 v238, v211 offset:384
    ds_read_b32 v242, v211 offset:512
    ds_read_b32 v246, v211 offset:640
    ds_read_b32 v250, v211 offset:768
    ds_read_b128 v[112:115], v176
    v_mfma_f32_32x32x16_bf16 v[32:47], v[156:159], v[144:147], v[32:47]
    ds_read_b128 v[116:119], v177
    ds_read_b128 v[120:123], v178
    ds_read_b128 v[124:127], v179
    ds_read_b64_tr_b16 v[128:129], v180 offset:0
    ds_read_b64_tr_b16 v[130:131], v180 offset:896
    ds_read_b64_tr_b16 v[132:133], v180 offset:3584
    v_mfma_f32_32x32x16_bf16 v[48:63], v[160:163], v[144:147], v[48:63]
    ds_read_b64_tr_b16 v[134:135], v180 offset:4480
    ds_read_b64_tr_b16 v[136:137], v180 offset:7168
    ds_read_b64_tr_b16 v[138:139], v180 offset:8064
    ds_read_b64_tr_b16 v[140:141], v180 offset:10752
    ds_read_b64_tr_b16 v[142:143], v180 offset:11648
    v_mfma_f32_32x32x16_bf16 v[64:79], v[164:167], v[144:147], v[64:79]
    s_waitcnt lgkmcnt(12)
    v_cmp_gt_u32 vcc, 32, v200
    v_mov_b32 v214, 0
    v_mov_b32 v215, 0
    v_xor_b32 v207, 0x80000000, v207
    v_cndmask_b32 v207, 0, v207, vcc
    v_mfma_f32_32x32x16_bf16 v[80:95], v[168:171], v[144:147], v[80:95]
    v_and_b32 v208, 0xffff0000, v207
    v_sub_f32 v209, v207, v208
    v_cvt_pk_bf16_f32 v212, v208, v209
    v_mov_b32 v213, v212
    v_rsq_f32 v208, v210
    v_lshlrev_b32 v206, 4, v200
    v_mfma_f32_32x32x16_bf16 v[96:111], v[172:175], v[144:147], v[96:111]
    v_mul_f32 v208, 0xbfb8aa3b, v208
    v_and_b32 v227, 0xffff0000, v226
    v_sub_f32 v226, v226, v227
    v_cvt_pk_bf16_f32 v224, v227, v227
    v_cvt_pk_bf16_f32 v225, v226, v226
    v_mov_b32 v226, 0
    s_nop 0
    s_waitcnt lgkmcnt(0)
    v_mfma_f32_32x32x16_bf16 v[0:15], v[224:227], v[212:215], v[0:15]
    ds_read_b64_tr_b16 v[184:185], v180 offset:32
    ds_read_b64_tr_b16 v[186:187], v180 offset:928
    ds_read_b64_tr_b16 v[188:189], v180 offset:3616
    ds_read_b64_tr_b16 v[190:191], v180 offset:4512
    ds_read_b64_tr_b16 v[192:193], v180 offset:7200
    ds_read_b64_tr_b16 v[194:195], v180 offset:8096
    ds_read_b64_tr_b16 v[196:197], v180 offset:10784
    ds_read_b64_tr_b16 v[198:199], v180 offset:11680
    v_mfma_f32_32x32x16_bf16 v[0:15], v[128:131], v[112:115], v[0:15]
    v_mfma_f32_32x32x16_bf16 v[0:15], v[132:135], v[116:119], v[0:15]
    v_mfma_f32_32x32x16_bf16 v[0:15], v[136:139], v[120:123], v[0:15]
    v_mfma_f32_32x32x16_bf16 v[0:15], v[140:143], v[124:127], v[0:15]
    v_and_b32 v231, 0xffff0000, v230
    v_sub_f32 v230, v230, v231
    v_cvt_pk_bf16_f32 v228, v231, v231
    v_cvt_pk_bf16_f32 v229, v230, v230
    v_mov_b32 v230, 0
    s_nop 7
    v_pk_mul_f32 v[144:145], v[0:1], v[208:209] op_sel_hi:[1,0]
    v_pk_mul_f32 v[146:147], v[2:3], v[208:209] op_sel_hi:[1,0]
    v_pk_mul_f32 v[148:149], v[4:5], v[208:209] op_sel_hi:[1,0]
    v_pk_mul_f32 v[150:151], v[6:7], v[208:209] op_sel_hi:[1,0]
    s_waitcnt lgkmcnt(0)
    v_mfma_f32_32x32x16_bf16 v[16:31], v[228:231], v[212:215], v[16:31]
    ds_read_b64_tr_b16 v[128:129], v180 offset:64
    ds_read_b64_tr_b16 v[130:131], v180 offset:960
    ds_read_b64_tr_b16 v[132:133], v180 offset:3648
    ds_read_b64_tr_b16 v[134:135], v180 offset:4544
    ds_read_b64_tr_b16 v[136:137], v180 offset:7232
    ds_read_b64_tr_b16 v[138:139], v180 offset:8128
    ds_read_b64_tr_b16 v[140:141], v180 offset:10816
    ds_read_b64_tr_b16 v[142:143], v180 offset:11712
    v_mfma_f32_32x32x16_bf16 v[16:31], v[184:187], v[112:115], v[16:31]
    v_exp_f32 v144, v144
    v_exp_f32 v145, v145
    v_mfma_f32_32x32x16_bf16 v[16:31], v[188:191], v[116:119], v[16:31]
    v_exp_f32 v146, v146
    v_exp_f32 v147, v147
    v_mfma_f32_32x32x16_bf16 v[16:31], v[192:195], v[120:123], v[16:31]
    v_exp_f32 v148, v148
    v_exp_f32 v149, v149
    v_mfma_f32_32x32x16_bf16 v[16:31], v[196:199], v[124:127], v[16:31]
    v_exp_f32 v150, v150
    v_exp_f32 v151, v151
    v_and_b32 v235, 0xffff0000, v234
    v_sub_f32 v234, v234, v235
    v_cvt_pk_bf16_f32 v232, v235, v235
    v_cvt_pk_bf16_f32 v233, v234, v234
    v_mov_b32 v234, 0
    v_pk_fma_f32 v[144:145], v[144:145], v[210:211], v[210:211] op_sel_hi:[1,0,0]
    v_pk_fma_f32 v[146:147], v[146:147], v[210:211], v[210:211] op_sel_hi:[1,0,0]
    v_pk_fma_f32 v[148:149], v[148:149], v[210:211], v[210:211] op_sel_hi:[1,0,0]
    v_pk_fma_f32 v[150:151], v[150:151], v[210:211], v[210:211] op_sel_hi:[1,0,0]
    v_pk_mul_f32 v[0:1], v[0:1], v[8:9]
    v_pk_mul_f32 v[2:3], v[2:3], v[10:11]
    v_pk_mul_f32 v[4:5], v[4:5], v[12:13]
    v_pk_mul_f32 v[6:7], v[6:7], v[14:15]
    v_pk_mul_f32 v[152:153], v[16:17], v[208:209] op_sel_hi:[1,0]
    v_pk_mul_f32 v[154:155], v[18:19], v[208:209] op_sel_hi:[1,0]
    v_pk_mul_f32 v[156:157], v[20:21], v[208:209] op_sel_hi:[1,0]
    v_pk_mul_f32 v[158:159], v[22:23], v[208:209] op_sel_hi:[1,0]
    s_waitcnt lgkmcnt(0)
    v_mfma_f32_32x32x16_bf16 v[32:47], v[232:235], v[212:215], v[32:47]
    ds_read_b64_tr_b16 v[184:185], v180 offset:96
    ds_read_b64_tr_b16 v[186:187], v180 offset:992
    ds_read_b64_tr_b16 v[188:189], v180 offset:3680
    ds_read_b64_tr_b16 v[190:191], v180 offset:4576
    ds_read_b64_tr_b16 v[192:193], v180 offset:7264
    ds_read_b64_tr_b16 v[194:195], v180 offset:8160
    ds_read_b64_tr_b16 v[196:197], v180 offset:10848
    ds_read_b64_tr_b16 v[198:199], v180 offset:11744
    v_mfma_f32_32x32x16_bf16 v[32:47], v[128:131], v[112:115], v[32:47]
    v_exp_f32 v152, v152
    v_exp_f32 v153, v153
    v_exp_f32 v154, v154
    v_exp_f32 v155, v155
    v_mfma_f32_32x32x16_bf16 v[32:47], v[132:135], v[116:119], v[32:47]
    v_exp_f32 v156, v156
    v_exp_f32 v157, v157
    v_exp_f32 v158, v158
    v_exp_f32 v159, v159
    v_mfma_f32_32x32x16_bf16 v[32:47], v[136:139], v[120:123], v[32:47]
    v_rcp_f32 v144, v144
    v_rcp_f32 v145, v145
    v_rcp_f32 v146, v146
    v_rcp_f32 v147, v147
    v_mfma_f32_32x32x16_bf16 v[32:47], v[140:143], v[124:127], v[32:47]
    v_rcp_f32 v148, v148
    v_rcp_f32 v149, v149
    v_rcp_f32 v150, v150
    v_rcp_f32 v151, v151
    v_and_b32 v239, 0xffff0000, v238
    v_sub_f32 v238, v238, v239
    v_cvt_pk_bf16_f32 v236, v239, v239
    v_cvt_pk_bf16_f32 v237, v238, v238
    v_mov_b32 v238, 0
    s_add_u32 s21, s53, 0
    v_pk_mul_f32 v[0:1], v[0:1], v[144:145]
    v_pk_mul_f32 v[2:3], v[2:3], v[146:147]
    v_pk_mul_f32 v[4:5], v[4:5], v[148:149]
    v_pk_mul_f32 v[6:7], v[6:7], v[150:151]
    v_cvt_pk_bf16_f32 v168, v0, v1
    v_cvt_pk_bf16_f32 v169, v2, v3
    v_cvt_pk_bf16_f32 v170, v4, v5
    v_cvt_pk_bf16_f32 v171, v6, v7
    buffer_store_dwordx4 v[168:171], v206, s[60:63], s21 offen sc1
    v_pk_fma_f32 v[152:153], v[152:153], v[210:211], v[210:211] op_sel_hi:[1,0,0]
    v_pk_fma_f32 v[154:155], v[154:155], v[210:211], v[210:211] op_sel_hi:[1,0,0]
    v_pk_fma_f32 v[156:157], v[156:157], v[210:211], v[210:211] op_sel_hi:[1,0,0]
    v_pk_fma_f32 v[158:159], v[158:159], v[210:211], v[210:211] op_sel_hi:[1,0,0]
    v_pk_mul_f32 v[16:17], v[16:17], v[24:25]
    v_pk_mul_f32 v[18:19], v[18:19], v[26:27]
    v_pk_mul_f32 v[20:21], v[20:21], v[28:29]
    v_pk_mul_f32 v[22:23], v[22:23], v[30:31]
    v_pk_mul_f32 v[144:145], v[32:33], v[208:209] op_sel_hi:[1,0]
    v_pk_mul_f32 v[146:147], v[34:35], v[208:209] op_sel_hi:[1,0]
    v_pk_mul_f32 v[148:149], v[36:37], v[208:209] op_sel_hi:[1,0]
    v_pk_mul_f32 v[150:151], v[38:39], v[208:209] op_sel_hi:[1,0]
    s_waitcnt lgkmcnt(0)
    v_mfma_f32_32x32x16_bf16 v[48:63], v[236:239], v[212:215], v[48:63]
    ds_read_b64_tr_b16 v[128:129], v180 offset:128
    ds_read_b64_tr_b16 v[130:131], v180 offset:1024
    ds_read_b64_tr_b16 v[132:133], v180 offset:3712
    ds_read_b64_tr_b16 v[134:135], v180 offset:4608
    ds_read_b64_tr_b16 v[136:137], v180 offset:7296
    ds_read_b64_tr_b16 v[138:139], v180 offset:8192
    ds_read_b64_tr_b16 v[140:141], v180 offset:10880
    ds_read_b64_tr_b16 v[142:143], v180 offset:11776
    v_mfma_f32_32x32x16_bf16 v[48:63], v[184:187], v[112:115], v[48:63]
    v_exp_f32 v144, v144
    v_exp_f32 v145, v145
    v_exp_f32 v146, v146
    v_exp_f32 v147, v147
    v_mfma_f32_32x32x16_bf16 v[48:63], v[188:191], v[116:119], v[48:63]
    v_exp_f32 v148, v148
    v_exp_f32 v149, v149
    v_exp_f32 v150, v150
    v_exp_f32 v151, v151
    v_mfma_f32_32x32x16_bf16 v[48:63], v[192:195], v[120:123], v[48:63]
    v_rcp_f32 v152, v152
    v_rcp_f32 v153, v153
    v_rcp_f32 v154, v154
    v_rcp_f32 v155, v155
    v_mfma_f32_32x32x16_bf16 v[48:63], v[196:199], v[124:127], v[48:63]
    v_rcp_f32 v156, v156
    v_rcp_f32 v157, v157
    v_rcp_f32 v158, v158
    v_rcp_f32 v159, v159
    v_and_b32 v243, 0xffff0000, v242
    v_sub_f32 v242, v242, v243
    v_cvt_pk_bf16_f32 v240, v243, v243
    v_cvt_pk_bf16_f32 v241, v242, v242
    v_mov_b32 v242, 0
    s_add_u32 s21, s53, 2048
    v_pk_mul_f32 v[16:17], v[16:17], v[152:153]
    v_pk_mul_f32 v[18:19], v[18:19], v[154:155]
    v_pk_mul_f32 v[20:21], v[20:21], v[156:157]
    v_pk_mul_f32 v[22:23], v[22:23], v[158:159]
    v_cvt_pk_bf16_f32 v172, v16, v17
    v_cvt_pk_bf16_f32 v173, v18, v19
    v_cvt_pk_bf16_f32 v174, v20, v21
    v_cvt_pk_bf16_f32 v175, v22, v23
    buffer_store_dwordx4 v[172:175], v206, s[60:63], s21 offen sc1
    v_pk_fma_f32 v[144:145], v[144:145], v[210:211], v[210:211] op_sel_hi:[1,0,0]
    v_pk_fma_f32 v[146:147], v[146:147], v[210:211], v[210:211] op_sel_hi:[1,0,0]
    v_pk_fma_f32 v[148:149], v[148:149], v[210:211], v[210:211] op_sel_hi:[1,0,0]
    v_pk_fma_f32 v[150:151], v[150:151], v[210:211], v[210:211] op_sel_hi:[1,0,0]
    v_pk_mul_f32 v[32:33], v[32:33], v[40:41]
    v_pk_mul_f32 v[34:35], v[34:35], v[42:43]
    v_pk_mul_f32 v[36:37], v[36:37], v[44:45]
    v_pk_mul_f32 v[38:39], v[38:39], v[46:47]
    v_pk_mul_f32 v[152:153], v[48:49], v[208:209] op_sel_hi:[1,0]
    v_pk_mul_f32 v[154:155], v[50:51], v[208:209] op_sel_hi:[1,0]
    v_pk_mul_f32 v[156:157], v[52:53], v[208:209] op_sel_hi:[1,0]
    v_pk_mul_f32 v[158:159], v[54:55], v[208:209] op_sel_hi:[1,0]
    s_waitcnt lgkmcnt(0)
    v_mfma_f32_32x32x16_bf16 v[64:79], v[240:243], v[212:215], v[64:79]
    ds_read_b64_tr_b16 v[184:185], v180 offset:160
    ds_read_b64_tr_b16 v[186:187], v180 offset:1056
    ds_read_b64_tr_b16 v[188:189], v180 offset:3744
    ds_read_b64_tr_b16 v[190:191], v180 offset:4640
    ds_read_b64_tr_b16 v[192:193], v180 offset:7328
    ds_read_b64_tr_b16 v[194:195], v180 offset:8224
    ds_read_b64_tr_b16 v[196:197], v180 offset:10912
    ds_read_b64_tr_b16 v[198:199], v180 offset:11808
    v_mfma_f32_32x32x16_bf16 v[64:79], v[128:131], v[112:115], v[64:79]
    v_exp_f32 v152, v152
    v_exp_f32 v153, v153
    v_exp_f32 v154, v154
    v_exp_f32 v155, v155
    v_mfma_f32_32x32x16_bf16 v[64:79], v[132:135], v[116:119], v[64:79]
    v_exp_f32 v156, v156
    v_exp_f32 v157, v157
    v_exp_f32 v158, v158
    v_exp_f32 v159, v159
    v_mfma_f32_32x32x16_bf16 v[64:79], v[136:139], v[120:123], v[64:79]
    v_rcp_f32 v144, v144
    v_rcp_f32 v145, v145
    v_rcp_f32 v146, v146
    v_rcp_f32 v147, v147
    v_mfma_f32_32x32x16_bf16 v[64:79], v[140:143], v[124:127], v[64:79]
    v_rcp_f32 v148, v148
    v_rcp_f32 v149, v149
    v_rcp_f32 v150, v150
    v_rcp_f32 v151, v151
    v_and_b32 v247, 0xffff0000, v246
    v_sub_f32 v246, v246, v247
    v_cvt_pk_bf16_f32 v244, v247, v247
    v_cvt_pk_bf16_f32 v245, v246, v246
    v_mov_b32 v246, 0
    s_add_u32 s21, s53, 4096
    v_pk_mul_f32 v[32:33], v[32:33], v[144:145]
    v_pk_mul_f32 v[34:35], v[34:35], v[146:147]
    v_pk_mul_f32 v[36:37], v[36:37], v[148:149]
    v_pk_mul_f32 v[38:39], v[38:39], v[150:151]
    v_cvt_pk_bf16_f32 v160, v32, v33
    v_cvt_pk_bf16_f32 v161, v34, v35
    v_cvt_pk_bf16_f32 v162, v36, v37
    v_cvt_pk_bf16_f32 v163, v38, v39
    buffer_store_dwordx4 v[160:163], v206, s[60:63], s21 offen sc1
    v_pk_fma_f32 v[152:153], v[152:153], v[210:211], v[210:211] op_sel_hi:[1,0,0]
    v_pk_fma_f32 v[154:155], v[154:155], v[210:211], v[210:211] op_sel_hi:[1,0,0]
    v_pk_fma_f32 v[156:157], v[156:157], v[210:211], v[210:211] op_sel_hi:[1,0,0]
    v_pk_fma_f32 v[158:159], v[158:159], v[210:211], v[210:211] op_sel_hi:[1,0,0]
    v_pk_mul_f32 v[48:49], v[48:49], v[56:57]
    v_pk_mul_f32 v[50:51], v[50:51], v[58:59]
    v_pk_mul_f32 v[52:53], v[52:53], v[60:61]
    v_pk_mul_f32 v[54:55], v[54:55], v[62:63]
    v_pk_mul_f32 v[144:145], v[64:65], v[208:209] op_sel_hi:[1,0]
    v_pk_mul_f32 v[146:147], v[66:67], v[208:209] op_sel_hi:[1,0]
    v_pk_mul_f32 v[148:149], v[68:69], v[208:209] op_sel_hi:[1,0]
    v_pk_mul_f32 v[150:151], v[70:71], v[208:209] op_sel_hi:[1,0]
    s_waitcnt lgkmcnt(0)
    v_mfma_f32_32x32x16_bf16 v[80:95], v[244:247], v[212:215], v[80:95]
    ds_read_b64_tr_b16 v[128:129], v180 offset:192
    ds_read_b64_tr_b16 v[130:131], v180 offset:1088
    ds_read_b64_tr_b16 v[132:133], v180 offset:3776
    ds_read_b64_tr_b16 v[134:135], v180 offset:4672
    ds_read_b64_tr_b16 v[136:137], v180 offset:7360
    ds_read_b64_tr_b16 v[138:139], v180 offset:8256
    ds_read_b64_tr_b16 v[140:141], v180 offset:10944
    ds_read_b64_tr_b16 v[142:143], v180 offset:11840
    v_mfma_f32_32x32x16_bf16 v[80:95], v[184:187], v[112:115], v[80:95]
    v_exp_f32 v144, v144
    v_exp_f32 v145, v145
    v_exp_f32 v146, v146
    v_exp_f32 v147, v147
    v_mfma_f32_32x32x16_bf16 v[80:95], v[188:191], v[116:119], v[80:95]
    v_exp_f32 v148, v148
    v_exp_f32 v149, v149
    v_exp_f32 v150, v150
    v_exp_f32 v151, v151
    v_mfma_f32_32x32x16_bf16 v[80:95], v[192:195], v[120:123], v[80:95]
    v_rcp_f32 v152, v152
    v_rcp_f32 v153, v153
    v_rcp_f32 v154, v154
    v_rcp_f32 v155, v155
    v_mfma_f32_32x32x16_bf16 v[80:95], v[196:199], v[124:127], v[80:95]
    v_rcp_f32 v156, v156
    v_rcp_f32 v157, v157
    v_rcp_f32 v158, v158
    v_rcp_f32 v159, v159
    v_and_b32 v251, 0xffff0000, v250
    v_sub_f32 v250, v250, v251
    v_cvt_pk_bf16_f32 v248, v251, v251
    v_cvt_pk_bf16_f32 v249, v250, v250
    v_mov_b32 v250, 0
    s_add_u32 s21, s53, 6144
    v_pk_mul_f32 v[48:49], v[48:49], v[152:153]
    v_pk_mul_f32 v[50:51], v[50:51], v[154:155]
    v_pk_mul_f32 v[52:53], v[52:53], v[156:157]
    v_pk_mul_f32 v[54:55], v[54:55], v[158:159]
    v_cvt_pk_bf16_f32 v164, v48, v49
    v_cvt_pk_bf16_f32 v165, v50, v51
    v_cvt_pk_bf16_f32 v166, v52, v53
    v_cvt_pk_bf16_f32 v167, v54, v55
    buffer_store_dwordx4 v[164:167], v206, s[60:63], s21 offen sc1
    v_pk_fma_f32 v[144:145], v[144:145], v[210:211], v[210:211] op_sel_hi:[1,0,0]
    v_pk_fma_f32 v[146:147], v[146:147], v[210:211], v[210:211] op_sel_hi:[1,0,0]
    v_pk_fma_f32 v[148:149], v[148:149], v[210:211], v[210:211] op_sel_hi:[1,0,0]
    v_pk_fma_f32 v[150:151], v[150:151], v[210:211], v[210:211] op_sel_hi:[1,0,0]
    v_pk_mul_f32 v[64:65], v[64:65], v[72:73]
    v_pk_mul_f32 v[66:67], v[66:67], v[74:75]
    v_pk_mul_f32 v[68:69], v[68:69], v[76:77]
    v_pk_mul_f32 v[70:71], v[70:71], v[78:79]
    v_pk_mul_f32 v[152:153], v[80:81], v[208:209] op_sel_hi:[1,0]
    v_pk_mul_f32 v[154:155], v[82:83], v[208:209] op_sel_hi:[1,0]
    v_pk_mul_f32 v[156:157], v[84:85], v[208:209] op_sel_hi:[1,0]
    v_pk_mul_f32 v[158:159], v[86:87], v[208:209] op_sel_hi:[1,0]
    s_waitcnt lgkmcnt(0)
    v_mfma_f32_32x32x16_bf16 v[96:111], v[248:251], v[212:215], v[96:111]
    v_mfma_f32_32x32x16_bf16 v[96:111], v[128:131], v[112:115], v[96:111]
    v_exp_f32 v152, v152
    v_exp_f32 v153, v153
    v_exp_f32 v154, v154
    v_exp_f32 v155, v155
    v_mfma_f32_32x32x16_bf16 v[96:111], v[132:135], v[116:119], v[96:111]
    v_exp_f32 v156, v156
    v_exp_f32 v157, v157
    v_exp_f32 v158, v158
    v_exp_f32 v159, v159
    v_mfma_f32_32x32x16_bf16 v[96:111], v[136:139], v[120:123], v[96:111]
    v_rcp_f32 v144, v144
    v_rcp_f32 v145, v145
    v_rcp_f32 v146, v146
    v_rcp_f32 v147, v147
    v_mfma_f32_32x32x16_bf16 v[96:111], v[140:143], v[124:127], v[96:111]
    v_rcp_f32 v148, v148
    v_rcp_f32 v149, v149
    v_rcp_f32 v150, v150
    v_rcp_f32 v151, v151
    s_add_u32 s21, s53, 8192
    v_pk_mul_f32 v[64:65], v[64:65], v[144:145]
    v_pk_mul_f32 v[66:67], v[66:67], v[146:147]
    v_pk_mul_f32 v[68:69], v[68:69], v[148:149]
    v_pk_mul_f32 v[70:71], v[70:71], v[150:151]
    v_cvt_pk_bf16_f32 v168, v64, v65
    v_cvt_pk_bf16_f32 v169, v66, v67
    v_cvt_pk_bf16_f32 v170, v68, v69
    v_cvt_pk_bf16_f32 v171, v70, v71
    buffer_store_dwordx4 v[168:171], v206, s[60:63], s21 offen sc1
    v_pk_fma_f32 v[152:153], v[152:153], v[210:211], v[210:211] op_sel_hi:[1,0,0]
    v_pk_fma_f32 v[154:155], v[154:155], v[210:211], v[210:211] op_sel_hi:[1,0,0]
    v_pk_fma_f32 v[156:157], v[156:157], v[210:211], v[210:211] op_sel_hi:[1,0,0]
    v_pk_fma_f32 v[158:159], v[158:159], v[210:211], v[210:211] op_sel_hi:[1,0,0]
    v_pk_mul_f32 v[80:81], v[80:81], v[88:89]
    v_pk_mul_f32 v[82:83], v[82:83], v[90:91]
    v_pk_mul_f32 v[84:85], v[84:85], v[92:93]
    v_pk_mul_f32 v[86:87], v[86:87], v[94:95]
    v_pk_mul_f32 v[144:145], v[96:97], v[208:209] op_sel_hi:[1,0]
    v_pk_mul_f32 v[146:147], v[98:99], v[208:209] op_sel_hi:[1,0]
    v_pk_mul_f32 v[148:149], v[100:101], v[208:209] op_sel_hi:[1,0]
    v_pk_mul_f32 v[150:151], v[102:103], v[208:209] op_sel_hi:[1,0]
    v_exp_f32 v144, v144
    v_exp_f32 v145, v145
    v_exp_f32 v146, v146
    v_exp_f32 v147, v147
    v_exp_f32 v148, v148
    v_exp_f32 v149, v149
    v_exp_f32 v150, v150
    v_exp_f32 v151, v151
    v_rcp_f32 v152, v152
    v_rcp_f32 v153, v153
    v_rcp_f32 v154, v154
    v_rcp_f32 v155, v155
    v_rcp_f32 v156, v156
    v_rcp_f32 v157, v157
    v_rcp_f32 v158, v158
    v_rcp_f32 v159, v159
    s_add_u32 s21, s53, 10240
    v_pk_mul_f32 v[80:81], v[80:81], v[152:153]
    v_pk_mul_f32 v[82:83], v[82:83], v[154:155]
    v_pk_mul_f32 v[84:85], v[84:85], v[156:157]
    v_pk_mul_f32 v[86:87], v[86:87], v[158:159]
    v_cvt_pk_bf16_f32 v172, v80, v81
    v_cvt_pk_bf16_f32 v173, v82, v83
    v_cvt_pk_bf16_f32 v174, v84, v85
    v_cvt_pk_bf16_f32 v175, v86, v87
    buffer_store_dwordx4 v[172:175], v206, s[56:59], s21 offen sc1
    v_pk_fma_f32 v[144:145], v[144:145], v[210:211], v[210:211] op_sel_hi:[1,0,0]
    v_pk_fma_f32 v[146:147], v[146:147], v[210:211], v[210:211] op_sel_hi:[1,0,0]
    v_pk_fma_f32 v[148:149], v[148:149], v[210:211], v[210:211] op_sel_hi:[1,0,0]
    v_pk_fma_f32 v[150:151], v[150:151], v[210:211], v[210:211] op_sel_hi:[1,0,0]
    v_pk_mul_f32 v[96:97], v[96:97], v[104:105]
    v_pk_mul_f32 v[98:99], v[98:99], v[106:107]
    v_pk_mul_f32 v[100:101], v[100:101], v[108:109]
    v_pk_mul_f32 v[102:103], v[102:103], v[110:111]
    v_rcp_f32 v144, v144
    v_rcp_f32 v145, v145
    v_rcp_f32 v146, v146
    v_rcp_f32 v147, v147
    v_rcp_f32 v148, v148
    v_rcp_f32 v149, v149
    v_rcp_f32 v150, v150
    v_rcp_f32 v151, v151
    s_add_u32 s21, s53, 12288
    v_pk_mul_f32 v[96:97], v[96:97], v[144:145]
    v_pk_mul_f32 v[98:99], v[98:99], v[146:147]
    v_pk_mul_f32 v[100:101], v[100:101], v[148:149]
    v_pk_mul_f32 v[102:103], v[102:103], v[150:151]
    v_cvt_pk_bf16_f32 v160, v96, v97
    v_cvt_pk_bf16_f32 v161, v98, v99
    v_cvt_pk_bf16_f32 v162, v100, v101
    v_cvt_pk_bf16_f32 v163, v102, v103
    buffer_store_dwordx4 v[160:163], v206, s[56:59], s21 offen sc1
    v_mov_b32 v201, 0
    s_cmp_eq_u32 s3, 0
    s_waitcnt vmcnt(0)
    s_barrier
    s_cbranch_scc0 cm_nf
    s_mov_b64 exec, 1
    buffer_store_dwordx2 v[202:203], v201, s[56:59], s55 offen sc1
    s_mov_b64 exec, -1
cm_nf:
    s_setprio 0
    s_branch p2_a
p2_a:
    v_lshrrev_b32 v205, 5, v200
    v_bfe_u32 v211, v200, 2, 2
    v_lshl_add_u32 v212, v205, 2, v211
    v_bfe_u32 v213, v200, 4, 1
    v_bfe_u32 v214, v200, 1, 1
    v_lshl_add_u32 v213, v213, 1, v214
    v_lshrrev_b32 v211, 1, v211
    v_lshl_add_u32 v213, v211, 2, v213
    v_lshlrev_b32 v212, 7, v212
    v_lshl_add_u32 v212, v213, 4, v212
    v_and_b32 v214, 1, v200
    v_lshl_add_u32 v212, v214, 3, v212
    s_lshl_b32 s36, s72, 12
    s_add_u32 s36, s36, 0
    v_add_u32 v120, s36, v212
    v_add_u32 v121, 65536, v120
    v_add_u32 v122, 131072, v120
    v_xor_b32 v123, 64, v120
    v_xor_b32 v124, 64, v121
    v_xor_b32 v125, 64, v122
    ds_read_b64_tr_b16 v[236:237], v120 offset:32768
    ds_read_b64_tr_b16 v[238:239], v120 offset:33792
    ds_read_b64_tr_b16 v[240:241], v123 offset:32768
    ds_read_b64_tr_b16 v[242:243], v123 offset:33792
    ds_read_b64_tr_b16 v[244:245], v120 offset:40960
    ds_read_b64_tr_b16 v[246:247], v120 offset:41984
    ds_read_b64_tr_b16 v[248:249], v123 offset:40960
    ds_read_b64_tr_b16 v[250:251], v123 offset:41984
    s_mov_b32 s44, s66
    s_and_b32 s45, s67, 0xffff
    s_mov_b32 s46, 0x200000
    s_mov_b32 s47, 0x00020000
    v_and_b32 v204, 31, v200
    v_lshlrev_b32 v225, 15, v204
    v_lshl_add_u32 v225, v205, 4, v225
    s_mul_i32 s23, s70, 176128
    s_add_u32 s10, s6, s23
    s_addc_u32 s11, s7, 0
    s_mov_b32 s48, s10
    s_and_b32 s49, s11, 0xffff
    s_mov_b32 s50, 0x2b000
    s_mov_b32 s51, 0x00020000
    s_lshl_b32 s21, s73, 10
    s_add_u32 s21, s21, s36
    v_lshl_add_u32 v224, v200, 4, s21
    s_lshl_b32 s77, s77, 13
    buffer_load_dwordx4 v[192:195], v225, s[24:27], s76 offen offset:0
    s_lshl_b32 s21, s73, 16
    s_lshl_b32 s23, s72, 12
    s_add_u32 s21, s21, s23
    s_add_u32 s21, s21, 49152
    v_lshl_add_u32 v211, v200, 4, s21
    s_lshl_b32 s21, s73, 16
    s_lshl_b32 s23, s72, 14
    s_add_u32 s21, s21, s23
    s_add_u32 s21, s21, 49152
    v_lshl_add_u32 v212, v200, 4, s21
    v_and_b32 v208, 31, v200
    s_lshl_b32 s21, s72, 2
    s_add_u32 s21, s21, 0
    v_add_u32 v209, s21, v205
    v_and_b32 v210, 7, v200
    v_xor_b32 v209, v209, v210
    v_lshlrev_b32 v209, 4, v209
    s_lshl_b32 s21, s73, 12
    s_add_u32 s21, s21, 147456
    v_lshl_add_u32 v208, v208, 7, s21
    v_add_u32 v213, v208, v209
    s_lshl_b32 s21, s3, 10
    s_add_u32 s21, s21, 147456
    v_lshl_add_u32 v214, v200, 4, s21
    v_lshrrev_b32 v208, 3, v200
    v_xor_b32 v210, v210, v208
    v_lshlrev_b32 v208, 15, v208
    v_lshl_add_u32 v215, v210, 4, v208
    s_lshl_b32 s38, s3, 18
    s_lshl_b32 s21, s70, 10
    s_add_u32 s38, s38, s21
    s_lshl_b32 s21, s71, 7
    s_add_u32 s38, s38, s21
    s_lshr_b32 s21, s70, 1
    s_lshl_b32 s21, s21, 4
    v_min_u32 v94, 12, v200
    v_add_u32 v94, s21, v94
    v_lshlrev_b32 v95, 7, v94
    s_mov_b32 s39, 0x980000
    s_waitcnt lgkmcnt(0)
    s_barrier
    s_cmp_eq_u32 s3, 0
    s_cbranch_scc0 p2_np
    s_mov_b32 s21, 0
    s_mov_b64 exec, 0x1fff
    s_sleep 8
p2_sp:
    buffer_load_dwordx2 v[92:93], v95, s[56:59], s39 offen sc1
p2_sq:
    s_waitcnt vmcnt(0)
    v_cmp_ne_u64 vcc, v[92:93], v[202:203]
    s_add_u32 s21, s21, 1
    s_nop 3
    s_cbranch_vccz p2_np
    s_mov_b64 exec, vcc
    s_sleep 8
    s_cmp_lt_u32 s21, 65536
    s_cbranch_scc1 p2_sp
p2_np:
    s_mov_b64 exec, -1
    s_waitcnt vmcnt(0)
    s_barrier
    buffer_load_dwordx4 v[32:35], v224, s[48:51], s77 offen sc1
    s_add_u32 s77, s77, 8192
    s_cmp_eq_u32 s77, 180224
    s_cselect_b32 s77, 0, s77
    buffer_load_dwordx4 v[36:39], v224, s[48:51], s77 offen sc1
    s_add_u32 s77, s77, 8192
    s_cmp_eq_u32 s77, 180224
    s_cselect_b32 s77, 0, s77
    buffer_load_dwordx4 v[40:43], v224, s[48:51], s77 offen sc1
    s_add_u32 s77, s77, 8192
    s_cmp_eq_u32 s77, 180224
    s_cselect_b32 s77, 0, s77
    buffer_load_dwordx4 v[44:47], v224, s[48:51], s77 offen sc1
    s_add_u32 s77, s77, 8192
    s_cmp_eq_u32 s77, 180224
    s_cselect_b32 s77, 0, s77
    buffer_load_dwordx4 v[48:51], v224, s[48:51], s77 offen sc1
    s_add_u32 s77, s77, 8192
    s_cmp_eq_u32 s77, 180224
    s_cselect_b32 s77, 0, s77
    buffer_load_dwordx4 v[52:55], v224, s[48:51], s77 offen sc1
    s_add_u32 s77, s77, 8192
    s_cmp_eq_u32 s77, 180224
    s_cselect_b32 s77, 0, s77
    s_waitcnt vmcnt(5) lgkmcnt(0)
    v_mfma_f32_32x32x16_bf16 v[0:15], v[236:239], v[32:35], 0
    v_mfma_f32_32x32x16_bf16 v[16:31], v[240:243], v[32:35], 0
    buffer_load_dwordx4 v[56:59], v224, s[48:51], s77 offen sc1
    s_add_u32 s77, s77, 8192
    s_cmp_eq_u32 s77, 180224
    s_cselect_b32 s77, 0, s77
    ds_read_b64_tr_b16 v[228:229], v121 offset:49152
    ds_read_b64_tr_b16 v[230:231], v121 offset:50176
    ds_read_b64_tr_b16 v[232:233], v124 offset:49152
    ds_read_b64_tr_b16 v[234:235], v124 offset:50176
    s_waitcnt vmcnt(5) lgkmcnt(4)
    v_mfma_f32_32x32x16_bf16 v[0:15], v[244:247], v[36:39], v[0:15]
    v_mfma_f32_32x32x16_bf16 v[16:31], v[248:251], v[36:39], v[16:31]
    buffer_load_dwordx4 v[60:63], v224, s[48:51], s77 offen sc1
    s_add_u32 s77, s77, 8192
    s_cmp_eq_u32 s77, 180224
    s_cselect_b32 s77, 0, s77
    ds_read_b64_tr_b16 v[236:237], v121 offset:57344
    ds_read_b64_tr_b16 v[238:239], v121 offset:58368
    ds_read_b64_tr_b16 v[240:241], v124 offset:57344
    ds_read_b64_tr_b16 v[242:243], v124 offset:58368
    s_waitcnt vmcnt(5) lgkmcnt(4)
    v_mfma_f32_32x32x16_bf16 v[0:15], v[228:231], v[40:43], v[0:15]
    v_mfma_f32_32x32x16_bf16 v[16:31], v[232:235], v[40:43], v[16:31]
    buffer_load_dwordx4 v[64:67], v224, s[48:51], s77 offen sc1
    s_add_u32 s77, s77, 8192
    s_cmp_eq_u32 s77, 180224
    s_cselect_b32 s77, 0, s77
    ds_read_b64_tr_b16 v[244:245], v122 offset:0
    ds_read_b64_tr_b16 v[246:247], v122 offset:1024
    ds_read_b64_tr_b16 v[248:249], v125 offset:0
    ds_read_b64_tr_b16 v[250:251], v125 offset:1024
    s_waitcnt vmcnt(5) lgkmcnt(4)
    v_mfma_f32_32x32x16_bf16 v[0:15], v[236:239], v[44:47], v[0:15]
    v_mfma_f32_32x32x16_bf16 v[16:31], v[240:243], v[44:47], v[16:31]
    buffer_load_dwordx4 v[68:71], v224, s[48:51], s77 offen sc1
    s_add_u32 s77, s77, 8192
    s_cmp_eq_u32 s77, 180224
    s_cselect_b32 s77, 0, s77
    ds_read_b64_tr_b16 v[228:229], v122 offset:8192
    ds_read_b64_tr_b16 v[230:231], v122 offset:9216
    ds_read_b64_tr_b16 v[232:233], v125 offset:8192
    ds_read_b64_tr_b16 v[234:235], v125 offset:9216
    s_waitcnt vmcnt(5) lgkmcnt(4)
    v_mfma_f32_32x32x16_bf16 v[0:15], v[244:247], v[48:51], v[0:15]
    v_mfma_f32_32x32x16_bf16 v[16:31], v[248:251], v[48:51], v[16:31]
    buffer_load_dwordx4 v[72:75], v224, s[48:51], s77 offen sc1
    s_add_u32 s77, s77, 8192
    s_cmp_eq_u32 s77, 180224
    s_cselect_b32 s77, 0, s77
    ds_read_b64_tr_b16 v[236:237], v122 offset:16384
    ds_read_b64_tr_b16 v[238:239], v122 offset:17408
    ds_read_b64_tr_b16 v[240:241], v125 offset:16384
    ds_read_b64_tr_b16 v[242:243], v125 offset:17408
    s_waitcnt vmcnt(5) lgkmcnt(4)
    v_mfma_f32_32x32x16_bf16 v[0:15], v[228:231], v[52:55], v[0:15]
    v_mfma_f32_32x32x16_bf16 v[16:31], v[232:235], v[52:55], v[16:31]
    buffer_load_dwordx4 v[76:79], v224, s[48:51], s77 offen sc1
    s_add_u32 s77, s77, 8192
    s_cmp_eq_u32 s77, 180224
    s_cselect_b32 s77, 0, s77
    ds_read_b64_tr_b16 v[244:245], v120 offset:0
    ds_read_b64_tr_b16 v[246:247], v120 offset:1024
    ds_read_b64_tr_b16 v[248:249], v123 offset:0
    ds_read_b64_tr_b16 v[250:251], v123 offset:1024
    s_waitcnt vmcnt(5) lgkmcnt(4)
    v_mfma_f32_32x32x16_bf16 v[0:15], v[236:239], v[56:59], v[0:15]
    v_mfma_f32_32x32x16_bf16 v[16:31], v[240:243], v[56:59], v[16:31]
    buffer_load_dwordx4 v[80:83], v224, s[48:51], s77 offen sc1
    s_add_u32 s77, s77, 8192
    s_cmp_eq_u32 s77, 180224
    s_cselect_b32 s77, 0, s77
    ds_read_b64_tr_b16 v[228:229], v120 offset:8192
    ds_read_b64_tr_b16 v[230:231], v120 offset:9216
    ds_read_b64_tr_b16 v[232:233], v123 offset:8192
    ds_read_b64_tr_b16 v[234:235], v123 offset:9216
    s_waitcnt vmcnt(5) lgkmcnt(4)
    v_mfma_f32_32x32x16_bf16 v[0:15], v[244:247], v[60:63], v[0:15]
    v_mfma_f32_32x32x16_bf16 v[16:31], v[248:251], v[60:63], v[16:31]
    buffer_load_dwordx4 v[84:87], v224, s[48:51], s77 offen sc1
    s_add_u32 s77, s77, 8192
    s_cmp_eq_u32 s77, 180224
    s_cselect_b32 s77, 0, s77
    ds_read_b64_tr_b16 v[236:237], v120 offset:49152
    ds_read_b64_tr_b16 v[238:239], v120 offset:50176
    ds_read_b64_tr_b16 v[240:241], v123 offset:49152
    ds_read_b64_tr_b16 v[242:243], v123 offset:50176
    s_waitcnt vmcnt(5) lgkmcnt(4)
    v_mfma_f32_32x32x16_bf16 v[0:15], v[228:231], v[64:67], v[0:15]
    v_mfma_f32_32x32x16_bf16 v[16:31], v[232:235], v[64:67], v[16:31]
    buffer_load_dwordx4 v[88:91], v224, s[48:51], s77 offen sc1
    s_add_u32 s77, s77, 8192
    s_cmp_eq_u32 s77, 180224
    s_cselect_b32 s77, 0, s77
    ds_read_b64_tr_b16 v[244:245], v120 offset:57344
    ds_read_b64_tr_b16 v[246:247], v120 offset:58368
    ds_read_b64_tr_b16 v[248:249], v123 offset:57344
    ds_read_b64_tr_b16 v[250:251], v123 offset:58368
    s_waitcnt vmcnt(5) lgkmcnt(4)
    v_mfma_f32_32x32x16_bf16 v[0:15], v[236:239], v[68:71], v[0:15]
    v_mfma_f32_32x32x16_bf16 v[16:31], v[240:243], v[68:71], v[16:31]
    buffer_load_dwordx4 v[92:95], v224, s[48:51], s77 offen sc1
    s_add_u32 s77, s77, 8192
    s_cmp_eq_u32 s77, 180224
    s_cselect_b32 s77, 0, s77
    v_permlane32_swap_b32 v192, v194
    v_permlane32_swap_b32 v193, v195
    s_mov_b32 s36, 0xbfb8aa3b
    s_nop 0
    v_lshlrev_b32 v196, 16, v192
    v_and_b32 v197, 0xffff0000, v192
    v_lshlrev_b32 v198, 16, v193
    v_and_b32 v199, 0xffff0000, v193
    v_lshlrev_b32 v216, 16, v194
    v_and_b32 v217, 0xffff0000, v194
    v_lshlrev_b32 v218, 16, v195
    v_and_b32 v219, 0xffff0000, v195
    ds_read_b64_tr_b16 v[228:229], v121 offset:0
    ds_read_b64_tr_b16 v[230:231], v121 offset:1024
    ds_read_b64_tr_b16 v[232:233], v124 offset:0
    ds_read_b64_tr_b16 v[234:235], v124 offset:1024
    s_waitcnt vmcnt(5) lgkmcnt(4)
    v_mfma_f32_32x32x16_bf16 v[0:15], v[244:247], v[72:75], v[0:15]
    v_mfma_f32_32x32x16_bf16 v[16:31], v[248:251], v[72:75], v[16:31]
    buffer_load_dwordx4 v[96:99], v224, s[48:51], s77 offen sc1
    s_add_u32 s77, s77, 8192
    s_cmp_eq_u32 s77, 180224
    s_cselect_b32 s77, 0, s77
    ds_read_b64_tr_b16 v[236:237], v121 offset:8192
    ds_read_b64_tr_b16 v[238:239], v121 offset:9216
    ds_read_b64_tr_b16 v[240:241], v124 offset:8192
    ds_read_b64_tr_b16 v[242:243], v124 offset:9216
    s_waitcnt vmcnt(5) lgkmcnt(4)
    v_mfma_f32_32x32x16_bf16 v[0:15], v[228:231], v[76:79], v[0:15]
    v_mfma_f32_32x32x16_bf16 v[16:31], v[232:235], v[76:79], v[16:31]
    buffer_load_dwordx4 v[100:103], v224, s[48:51], s77 offen sc1
    s_add_u32 s77, s77, 8192
    s_cmp_eq_u32 s77, 180224
    s_cselect_b32 s77, 0, s77
    ds_read_b64_tr_b16 v[244:245], v120 offset:16384
    ds_read_b64_tr_b16 v[246:247], v120 offset:17408
    ds_read_b64_tr_b16 v[248:249], v123 offset:16384
    ds_read_b64_tr_b16 v[250:251], v123 offset:17408
    s_waitcnt vmcnt(5) lgkmcnt(4)
    v_mfma_f32_32x32x16_bf16 v[0:15], v[236:239], v[80:83], v[0:15]
    v_mfma_f32_32x32x16_bf16 v[16:31], v[240:243], v[80:83], v[16:31]
    buffer_load_dwordx4 v[32:35], v224, s[48:51], s77 offen sc1
    s_add_u32 s77, s77, 8192
    s_cmp_eq_u32 s77, 180224
    s_cselect_b32 s77, 0, s77
    ds_read_b64_tr_b16 v[228:229], v120 offset:24576
    ds_read_b64_tr_b16 v[230:231], v120 offset:25600
    ds_read_b64_tr_b16 v[232:233], v123 offset:24576
    ds_read_b64_tr_b16 v[234:235], v123 offset:25600
    s_waitcnt vmcnt(5) lgkmcnt(4)
    v_mfma_f32_32x32x16_bf16 v[0:15], v[244:247], v[84:87], v[0:15]
    v_mfma_f32_32x32x16_bf16 v[16:31], v[248:251], v[84:87], v[16:31]
    buffer_load_dwordx4 v[36:39], v224, s[48:51], s77 offen sc1
    s_add_u32 s77, s77, 8192
    s_cmp_eq_u32 s77, 180224
    s_cselect_b32 s77, 0, s77
    s_barrier
    ds_read_b64_tr_b16 v[236:237], v121 offset:16384
    ds_read_b64_tr_b16 v[238:239], v121 offset:17408
    ds_read_b64_tr_b16 v[240:241], v124 offset:16384
    ds_read_b64_tr_b16 v[242:243], v124 offset:17408
    s_waitcnt vmcnt(5) lgkmcnt(4)
    v_mfma_f32_32x32x16_bf16 v[0:15], v[228:231], v[88:91], v[0:15]
    v_mfma_f32_32x32x16_bf16 v[16:31], v[232:235], v[88:91], v[16:31]
    buffer_load_dwordx4 v[40:43], v224, s[48:51], s77 offen sc1
    s_add_u32 s77, s77, 8192
    s_cmp_eq_u32 s77, 180224
    s_cselect_b32 s77, 0, s77
    ds_read_b64_tr_b16 v[244:245], v121 offset:24576
    ds_read_b64_tr_b16 v[246:247], v121 offset:25600
    ds_read_b64_tr_b16 v[248:249], v124 offset:24576
    ds_read_b64_tr_b16 v[250:251], v124 offset:25600
    s_waitcnt vmcnt(5) lgkmcnt(4)
    v_mfma_f32_32x32x16_bf16 v[0:15], v[236:239], v[92:95], v[0:15]
    v_mfma_f32_32x32x16_bf16 v[16:31], v[240:243], v[92:95], v[16:31]
    buffer_load_dwordx4 v[44:47], v224, s[48:51], s77 offen sc1
    s_add_u32 s77, s77, 8192
    s_cmp_eq_u32 s77, 180224
    s_cselect_b32 s77, 0, s77
    ds_read_b64_tr_b16 v[228:229], v121 offset:32768
    ds_read_b64_tr_b16 v[230:231], v121 offset:33792
    ds_read_b64_tr_b16 v[232:233], v124 offset:32768
    ds_read_b64_tr_b16 v[234:235], v124 offset:33792
    s_waitcnt vmcnt(5) lgkmcnt(4)
    v_mfma_f32_32x32x16_bf16 v[0:15], v[244:247], v[96:99], v[0:15]
    v_mfma_f32_32x32x16_bf16 v[16:31], v[248:251], v[96:99], v[16:31]
    ds_read_b64_tr_b16 v[236:237], v121 offset:40960
    ds_read_b64_tr_b16 v[238:239], v121 offset:41984
    ds_read_b64_tr_b16 v[240:241], v124 offset:40960
    ds_read_b64_tr_b16 v[242:243], v124 offset:41984
    s_waitcnt vmcnt(4) lgkmcnt(4)
    v_mfma_f32_32x32x16_bf16 v[0:15], v[228:231], v[100:103], v[0:15]
    v_mfma_f32_32x32x16_bf16 v[16:31], v[232:235], v[100:103], v[16:31]
    ds_read_b64_tr_b16 v[244:245], v122 offset:24576
    ds_read_b64_tr_b16 v[246:247], v122 offset:25600
    ds_read_b64_tr_b16 v[248:249], v125 offset:24576
    ds_read_b64_tr_b16 v[250:251], v125 offset:25600
    s_waitcnt vmcnt(3) lgkmcnt(4)
    v_mfma_f32_32x32x16_bf16 v[0:15], v[236:239], v[32:35], v[0:15]
    v_mfma_f32_32x32x16_bf16 v[16:31], v[240:243], v[32:35], v[16:31]
    ds_read_b64_tr_b16 v[228:229], v120 offset:32768
    ds_read_b64_tr_b16 v[230:231], v120 offset:33792
    ds_read_b64_tr_b16 v[232:233], v123 offset:32768
    ds_read_b64_tr_b16 v[234:235], v123 offset:33792
    s_waitcnt vmcnt(2) lgkmcnt(4)
    v_mfma_f32_32x32x16_bf16 v[0:15], v[244:247], v[36:39], v[0:15]
    v_mfma_f32_32x32x16_bf16 v[16:31], v[248:251], v[36:39], v[16:31]
    ds_read_b64_tr_b16 v[236:237], v120 offset:40960
    ds_read_b64_tr_b16 v[238:239], v120 offset:41984
    ds_read_b64_tr_b16 v[240:241], v123 offset:40960
    ds_read_b64_tr_b16 v[242:243], v123 offset:41984
    s_waitcnt vmcnt(1) lgkmcnt(4)
    v_mfma_f32_32x32x16_bf16 v[0:15], v[228:231], v[40:43], v[0:15]
    v_mfma_f32_32x32x16_bf16 v[16:31], v[232:235], v[40:43], v[16:31]
    s_waitcnt vmcnt(0) lgkmcnt(0)
    v_mfma_f32_32x32x16_bf16 v[0:15], v[236:239], v[44:47], v[0:15]
    v_mfma_f32_32x32x16_bf16 v[16:31], v[240:243], v[44:47], v[16:31]
    s_nop 7
    s_nop 1
    s_cmp_eq_u32 s72, 0
    s_cbranch_scc0 p2_a_e1
    ds_write_b128 v211, v[8:11] offset:8192
    ds_write_b128 v211, v[12:15] offset:9216
    ds_write_b128 v211, v[16:19] offset:16384
    ds_write_b128 v211, v[20:23] offset:17408
    ds_write_b128 v211, v[24:27] offset:24576
    ds_write_b128 v211, v[28:31] offset:25600
    s_waitcnt lgkmcnt(0)
    s_barrier
    ds_read_b128 v[32:35], v212 offset:2048
    ds_read_b128 v[36:39], v212 offset:3072
    ds_read_b128 v[40:43], v212 offset:4096
    ds_read_b128 v[44:47], v212 offset:5120
    ds_read_b128 v[48:51], v212 offset:6144
    ds_read_b128 v[52:55], v212 offset:7168
    ds_read_b128 v[80:83], v212 offset:10240
    ds_read_b128 v[84:87], v212 offset:11264
    s_waitcnt lgkmcnt(6)
    v_pk_add_f32 v[72:73], v[0:1], v[32:33]
    v_pk_add_f32 v[74:75], v[2:3], v[34:35]
    v_pk_add_f32 v[76:77], v[4:5], v[36:37]
    v_pk_add_f32 v[78:79], v[6:7], v[38:39]
    s_branch p2_a_e2
p2_a_e1:
    ds_write_b128 v211, v[0:3] offset:0
    ds_write_b128 v211, v[4:7] offset:1024
    ds_write_b128 v211, v[8:11] offset:8192
    ds_write_b128 v211, v[12:15] offset:9216
    ds_write_b128 v211, v[24:27] offset:24576
    ds_write_b128 v211, v[28:31] offset:25600
    s_waitcnt lgkmcnt(0)
    s_barrier
    ds_read_b128 v[32:35], v212 offset:0
    ds_read_b128 v[36:39], v212 offset:1024
    ds_read_b128 v[40:43], v212 offset:2048
    ds_read_b128 v[44:47], v212 offset:3072
    ds_read_b128 v[48:51], v212 offset:6144
    ds_read_b128 v[52:55], v212 offset:7168
    ds_read_b128 v[80:83], v212 offset:14336
    ds_read_b128 v[84:87], v212 offset:15360
    s_waitcnt lgkmcnt(6)
    v_pk_add_f32 v[72:73], v[16:17], v[32:33]
    v_pk_add_f32 v[74:75], v[18:19], v[34:35]
    v_pk_add_f32 v[76:77], v[20:21], v[36:37]
    v_pk_add_f32 v[78:79], v[22:23], v[38:39]
p2_a_e2:
    s_waitcnt lgkmcnt(0)
    v_pk_add_f32 v[40:41], v[40:41], v[48:49]
    v_pk_add_f32 v[42:43], v[42:43], v[50:51]
    v_pk_add_f32 v[44:45], v[44:45], v[52:53]
    v_pk_add_f32 v[46:47], v[46:47], v[54:55]
    v_pk_add_f32 v[72:73], v[72:73], v[40:41]
    v_pk_add_f32 v[74:75], v[74:75], v[42:43]
    v_pk_add_f32 v[76:77], v[76:77], v[44:45]
    v_pk_add_f32 v[78:79], v[78:79], v[46:47]
    v_mul_f32 v32, s36, v72
    v_mul_f32 v33, s36, v73
    v_mul_f32 v34, s36, v74
    v_mul_f32 v35, s36, v75
    v_mul_f32 v36, s36, v76
    v_mul_f32 v37, s36, v77
    v_mul_f32 v38, s36, v78
    v_mul_f32 v39, s36, v79
    v_exp_f32 v32, v32
    v_exp_f32 v33, v33
    v_exp_f32 v34, v34
    v_exp_f32 v35, v35
    v_exp_f32 v36, v36
    v_exp_f32 v37, v37
    v_exp_f32 v38, v38
    v_exp_f32 v39, v39
    v_pk_mul_f32 v[72:73], v[72:73], v[80:81]
    v_pk_mul_f32 v[74:75], v[74:75], v[82:83]
    v_pk_mul_f32 v[76:77], v[76:77], v[84:85]
    v_pk_mul_f32 v[78:79], v[78:79], v[86:87]
    v_pk_add_f32 v[32:33], v[32:33], 1.0 op_sel_hi:[1,0]
    v_pk_add_f32 v[34:35], v[34:35], 1.0 op_sel_hi:[1,0]
    v_pk_add_f32 v[36:37], v[36:37], 1.0 op_sel_hi:[1,0]
    v_pk_add_f32 v[38:39], v[38:39], 1.0 op_sel_hi:[1,0]
    v_rcp_f32 v32, v32
    v_rcp_f32 v33, v33
    v_rcp_f32 v34, v34
    v_rcp_f32 v35, v35
    v_rcp_f32 v36, v36
    v_rcp_f32 v37, v37
    v_rcp_f32 v38, v38
    v_rcp_f32 v39, v39
    s_nop 0
    v_pk_fma_f32 v[72:73], v[72:73], v[32:33], v[196:197]
    v_pk_fma_f32 v[74:75], v[74:75], v[34:35], v[198:199]
    v_pk_fma_f32 v[76:77], v[76:77], v[36:37], v[216:217]
    v_pk_fma_f32 v[78:79], v[78:79], v[38:39], v[218:219]
    v_cvt_pk_bf16_f32 v192, v72, v73
    v_cvt_pk_bf16_f32 v193, v74, v75
    v_cvt_pk_bf16_f32 v194, v76, v77
    v_cvt_pk_bf16_f32 v195, v78, v79
    s_nop 1
    v_permlane32_swap_b32 v192, v194
    v_permlane32_swap_b32 v193, v195
    ds_write_b128 v213, v[192:195]
    s_waitcnt lgkmcnt(0)
    s_barrier
    ds_read_b128 v[192:195], v214
    s_waitcnt lgkmcnt(0)
    buffer_store_dwordx4 v[192:195], v215, s[44:47], s38 offen sc1
    s_endpgm
p2_b:
    v_lshrrev_b32 v205, 5, v200
    v_bfe_u32 v211, v200, 2, 2
    v_lshl_add_u32 v212, v205, 2, v211
    v_bfe_u32 v213, v200, 4, 1
    v_bfe_u32 v214, v200, 1, 1
    v_lshl_add_u32 v213, v213, 1, v214
    v_lshrrev_b32 v211, 1, v211
    v_lshl_add_u32 v213, v211, 2, v213
    v_lshlrev_b32 v212, 7, v212
    v_lshl_add_u32 v212, v213, 4, v212
    v_and_b32 v214, 1, v200
    v_lshl_add_u32 v212, v214, 3, v212
    s_lshl_b32 s36, s72, 12
    s_add_u32 s36, s36, 2048
    v_add_u32 v120, s36, v212
    v_add_u32 v121, 65536, v120
    v_add_u32 v122, 131072, v120
    v_xor_b32 v123, 64, v120
    v_xor_b32 v124, 64, v121
    v_xor_b32 v125, 64, v122
    ds_read_b64_tr_b16 v[236:237], v120 offset:32768
    ds_read_b64_tr_b16 v[238:239], v120 offset:33792
    ds_read_b64_tr_b16 v[240:241], v123 offset:32768
    ds_read_b64_tr_b16 v[242:243], v123 offset:33792
    ds_read_b64_tr_b16 v[244:245], v120 offset:40960
    ds_read_b64_tr_b16 v[246:247], v120 offset:41984
    ds_read_b64_tr_b16 v[248:249], v123 offset:40960
    ds_read_b64_tr_b16 v[250:251], v123 offset:41984
    s_mul_i32 s23, s70, 176128
    s_add_u32 s10, s6, s23
    s_addc_u32 s11, s7, 0
    s_mov_b32 s48, s10
    s_and_b32 s49, s11, 0xffff
    s_mov_b32 s50, 0x2b000
    s_mov_b32 s51, 0x00020000
    s_lshl_b32 s21, s73, 10
    s_add_u32 s21, s21, s36
    v_lshl_add_u32 v224, v200, 4, s21
    s_lshl_b32 s77, s77, 13
    v_and_b32 v204, 31, v200
    s_lshl_b32 s36, s71, 6
    s_lshl_b32 s37, s72, 5
    s_add_u32 s36, s36, s37
    v_add_u32 v206, s36, v204
    v_sub_u32 v207, 512, v206
    s_sub_u32 s37, 32, s70
    s_and_b32 s37, s37, 31
    s_cmp_lt_u32 s71, 4
    s_cselect_b32 s37, s70, s37
    s_cselect_b64 vcc, -1, 0
    v_cndmask_b32 v206, v207, v206, vcc
    v_mul_u32_u24 v207, 4608, v205
    v_lshl_add_u32 v206, v206, 4, v207
    s_mul_i32 s37, s37, 73728
    s_add_u32 s37, s37, 0x600000
    buffer_load_dwordx4 v[192:195], v225, s[24:27], s76 offen offset:32
    s_lshl_b32 s21, s73, 16
    s_lshl_b32 s23, s72, 12
    s_add_u32 s21, s21, s23
    s_add_u32 s21, s21, 51200
    v_lshl_add_u32 v211, v200, 4, s21
    s_lshl_b32 s21, s73, 16
    s_lshl_b32 s23, s72, 14
    s_add_u32 s21, s21, s23
    s_add_u32 s21, s21, 57344
    v_lshl_add_u32 v212, v200, 4, s21
    v_and_b32 v208, 31, v200
    s_lshl_b32 s21, s72, 2
    s_add_u32 s21, s21, 2
    v_add_u32 v209, s21, v205
    v_and_b32 v210, 7, v200
    v_xor_b32 v209, v209, v210
    v_lshlrev_b32 v209, 4, v209
    s_lshl_b32 s21, s73, 12
    s_add_u32 s21, s21, 147456
    v_lshl_add_u32 v208, v208, 7, s21
    v_add_u32 v213, v208, v209
    s_lshl_b32 s21, s3, 10
    s_add_u32 s21, s21, 147456
    v_lshl_add_u32 v214, v200, 4, s21
    v_lshrrev_b32 v208, 3, v200
    v_xor_b32 v210, v210, v208
    v_lshlrev_b32 v208, 15, v208
    v_lshl_add_u32 v215, v210, 4, v208
    s_lshl_b32 s38, s3, 18
    s_lshl_b32 s21, s70, 10
    s_add_u32 s38, s38, s21
    s_lshl_b32 s21, s71, 7
    s_add_u32 s38, s38, s21
    s_waitcnt lgkmcnt(0)
    s_barrier
    s_lshl_b32 s53, s74, 16
    s_add_u32 s53, s53, s75
    s_add_u32 m0, s22, 16384
    s_add_u32 s74, s74, 1
    s_cmp_eq_u32 s74, 22
    s_cselect_b32 s74, 0, s74
    buffer_load_dwordx4 v220, s[32:35], s53 offen offset:0 lds
    buffer_load_dwordx4 v221, s[32:35], s53 offen offset:1024 lds
    s_lshl_b32 s53, s74, 16
    s_add_u32 s53, s53, s75
    s_add_u32 m0, s22, 24576
    s_add_u32 s74, s74, 1
    s_cmp_eq_u32 s74, 22
    s_cselect_b32 s74, 0, s74
    buffer_load_dwordx4 v220, s[32:35], s53 offen offset:0 lds
    buffer_load_dwordx4 v221, s[32:35], s53 offen offset:1024 lds
    s_lshl_b32 s53, s74, 16
    s_add_u32 s53, s53, s75
    s_add_u32 m0, s22, 81920
    s_add_u32 s74, s74, 1
    s_cmp_eq_u32 s74, 22
    s_cselect_b32 s74, 0, s74
    buffer_load_dwordx4 v220, s[32:35], s53 offen offset:0 lds
    buffer_load_dwordx4 v221, s[32:35], s53 offen offset:1024 lds
    s_lshl_b32 s53, s74, 16
    s_add_u32 s53, s53, s75
    s_add_u32 m0, s22, 90112
    s_add_u32 s74, s74, 1
    s_cmp_eq_u32 s74, 22
    s_cselect_b32 s74, 0, s74
    buffer_load_dwordx4 v220, s[32:35], s53 offen offset:0 lds
    buffer_load_dwordx4 v221, s[32:35], s53 offen offset:1024 lds
    s_lshl_b32 s53, s74, 16
    s_add_u32 s53, s53, s75
    s_add_u32 m0, s22, 98304
    s_add_u32 s74, s74, 1
    s_cmp_eq_u32 s74, 22
    s_cselect_b32 s74, 0, s74
    buffer_load_dwordx4 v220, s[32:35], s53 offen offset:0 lds
    buffer_load_dwordx4 v221, s[32:35], s53 offen offset:1024 lds
    s_lshl_b32 s53, s74, 16
    s_add_u32 s53, s53, s75
    s_add_u32 m0, s22, 106496
    s_add_u32 s74, s74, 1
    s_cmp_eq_u32 s74, 22
    s_cselect_b32 s74, 0, s74
    buffer_load_dwordx4 v220, s[32:35], s53 offen offset:0 lds
    buffer_load_dwordx4 v221, s[32:35], s53 offen offset:1024 lds
    s_lshl_b32 s53, s74, 16
    s_add_u32 s53, s53, s75
    s_add_u32 m0, s22, 155648
    s_add_u32 s74, s74, 1
    s_cmp_eq_u32 s74, 22
    s_cselect_b32 s74, 0, s74
    buffer_load_dwordx4 v220, s[32:35], s53 offen offset:0 lds
    buffer_load_dwordx4 v221, s[32:35], s53 offen offset:1024 lds
    s_lshl_b32 s53, s74, 16
    s_add_u32 s53, s53, s75
    s_add_u32 m0, s22, 32768
    s_add_u32 s74, s74, 1
    s_cmp_eq_u32 s74, 22
    s_cselect_b32 s74, 0, s74
    buffer_load_dwordx4 v220, s[32:35], s53 offen offset:0 lds
    buffer_load_dwordx4 v221, s[32:35], s53 offen offset:1024 lds
    s_lshl_b32 s53, s74, 16
    s_add_u32 s53, s53, s75
    s_add_u32 m0, s22, 40960
    s_add_u32 s74, s74, 1
    s_cmp_eq_u32 s74, 22
    s_cselect_b32 s74, 0, s74
    buffer_load_dwordx4 v220, s[32:35], s53 offen offset:0 lds
    buffer_load_dwordx4 v221, s[32:35], s53 offen offset:1024 lds
    s_lshr_b32 s21, s36, 5
    s_sub_u32 s23, 16, s21
    s_sub_u32 s39, 15, s21
    s_cmp_lt_u32 s71, 4
    s_cselect_b32 s23, s21, s23
    s_cselect_b32 s39, s21, s39
    s_mul_i32 s23, s23, 86
    s_lshr_b32 s23, s23, 8
    s_mul_i32 s39, s39, 86
    s_lshr_b32 s39, s39, 8
    v_mov_b32 v126, s23
    v_mov_b32 v127, s39
    v_cmp_gt_u32 vcc, 16, v200
    v_and_b32 v94, 15, v200
    s_mov_b32 s39, 0x980680
    s_nop 0
    v_cndmask_b32 v126, v127, v126, vcc
    v_lshl_add_u32 v126, v94, 4, v126
    v_lshlrev_b32 v126, 7, v126
    s_waitcnt vmcnt(14)
    s_barrier
    buffer_load_dwordx4 v[32:35], v224, s[48:51], s77 offen sc1
    s_add_u32 s77, s77, 8192
    s_cmp_eq_u32 s77, 180224
    s_cselect_b32 s77, 0, s77
    buffer_load_dwordx4 v[36:39], v224, s[48:51], s77 offen sc1
    s_add_u32 s77, s77, 8192
    s_cmp_eq_u32 s77, 180224
    s_cselect_b32 s77, 0, s77
    buffer_load_dwordx4 v[40:43], v224, s[48:51], s77 offen sc1
    s_add_u32 s77, s77, 8192
    s_cmp_eq_u32 s77, 180224
    s_cselect_b32 s77, 0, s77
    buffer_load_dwordx4 v[44:47], v224, s[48:51], s77 offen sc1
    s_add_u32 s77, s77, 8192
    s_cmp_eq_u32 s77, 180224
    s_cselect_b32 s77, 0, s77
    buffer_load_dwordx4 v[48:51], v224, s[48:51], s77 offen sc1
    s_add_u32 s77, s77, 8192
    s_cmp_eq_u32 s77, 180224
    s_cselect_b32 s77, 0, s77
    buffer_load_dwordx4 v[52:55], v224, s[48:51], s77 offen sc1
    s_add_u32 s77, s77, 8192
    s_cmp_eq_u32 s77, 180224
    s_cselect_b32 s77, 0, s77
    s_waitcnt vmcnt(5) lgkmcnt(0)
    v_mfma_f32_32x32x16_bf16 v[0:15], v[236:239], v[32:35], 0
    v_mfma_f32_32x32x16_bf16 v[16:31], v[240:243], v[32:35], 0
    buffer_load_dwordx4 v[56:59], v224, s[48:51], s77 offen sc1
    s_add_u32 s77, s77, 8192
    s_cmp_eq_u32 s77, 180224
    s_cselect_b32 s77, 0, s77
    ds_read_b64_tr_b16 v[228:229], v121 offset:49152
    ds_read_b64_tr_b16 v[230:231], v121 offset:50176
    ds_read_b64_tr_b16 v[232:233], v124 offset:49152
    ds_read_b64_tr_b16 v[234:235], v124 offset:50176
    s_waitcnt vmcnt(5) lgkmcnt(4)
    v_mfma_f32_32x32x16_bf16 v[0:15], v[244:247], v[36:39], v[0:15]
    v_mfma_f32_32x32x16_bf16 v[16:31], v[248:251], v[36:39], v[16:31]
    buffer_load_dwordx4 v[60:63], v224, s[48:51], s77 offen sc1
    s_add_u32 s77, s77, 8192
    s_cmp_eq_u32 s77, 180224
    s_cselect_b32 s77, 0, s77
    buffer_load_dwordx2 v[252:253], v126, s[56:59], s39 offen sc1
    ds_read_b64_tr_b16 v[236:237], v121 offset:57344
    ds_read_b64_tr_b16 v[238:239], v121 offset:58368
    ds_read_b64_tr_b16 v[240:241], v124 offset:57344
    ds_read_b64_tr_b16 v[242:243], v124 offset:58368
    s_waitcnt vmcnt(6) lgkmcnt(4)
    v_mfma_f32_32x32x16_bf16 v[0:15], v[228:231], v[40:43], v[0:15]
    v_mfma_f32_32x32x16_bf16 v[16:31], v[232:235], v[40:43], v[16:31]
    buffer_load_dwordx4 v[64:67], v224, s[48:51], s77 offen sc1
    s_add_u32 s77, s77, 8192
    s_cmp_eq_u32 s77, 180224
    s_cselect_b32 s77, 0, s77
    ds_read_b64_tr_b16 v[244:245], v122 offset:0
    ds_read_b64_tr_b16 v[246:247], v122 offset:1024
    ds_read_b64_tr_b16 v[248:249], v125 offset:0
    ds_read_b64_tr_b16 v[250:251], v125 offset:1024
    s_waitcnt vmcnt(6) lgkmcnt(4)
    v_mfma_f32_32x32x16_bf16 v[0:15], v[236:239], v[44:47], v[0:15]
    v_mfma_f32_32x32x16_bf16 v[16:31], v[240:243], v[44:47], v[16:31]
    buffer_load_dwordx4 v[68:71], v224, s[48:51], s77 offen sc1
    s_add_u32 s77, s77, 8192
    s_cmp_eq_u32 s77, 180224
    s_cselect_b32 s77, 0, s77
    ds_read_b64_tr_b16 v[228:229], v122 offset:8192
    ds_read_b64_tr_b16 v[230:231], v122 offset:9216
    ds_read_b64_tr_b16 v[232:233], v125 offset:8192
    ds_read_b64_tr_b16 v[234:235], v125 offset:9216
    s_waitcnt vmcnt(6) lgkmcnt(4)
    v_mfma_f32_32x32x16_bf16 v[0:15], v[244:247], v[48:51], v[0:15]
    v_mfma_f32_32x32x16_bf16 v[16:31], v[248:251], v[48:51], v[16:31]
    buffer_load_dwordx4 v[72:75], v224, s[48:51], s77 offen sc1
    s_add_u32 s77, s77, 8192
    s_cmp_eq_u32 s77, 180224
    s_cselect_b32 s77, 0, s77
    ds_read_b64_tr_b16 v[236:237], v122 offset:16384
    ds_read_b64_tr_b16 v[238:239], v122 offset:17408
    ds_read_b64_tr_b16 v[240:241], v125 offset:16384
    ds_read_b64_tr_b16 v[242:243], v125 offset:17408
    s_waitcnt vmcnt(6) lgkmcnt(4)
    v_mfma_f32_32x32x16_bf16 v[0:15], v[228:231], v[52:55], v[0:15]
    v_mfma_f32_32x32x16_bf16 v[16:31], v[232:235], v[52:55], v[16:31]
    buffer_load_dwordx4 v[76:79], v224, s[48:51], s77 offen sc1
    s_add_u32 s77, s77, 8192
    s_cmp_eq_u32 s77, 180224
    s_cselect_b32 s77, 0, s77
    ds_read_b64_tr_b16 v[244:245], v120 offset:0
    ds_read_b64_tr_b16 v[246:247], v120 offset:1024
    ds_read_b64_tr_b16 v[248:249], v123 offset:0
    ds_read_b64_tr_b16 v[250:251], v123 offset:1024
    s_waitcnt vmcnt(6) lgkmcnt(4)
    v_mfma_f32_32x32x16_bf16 v[0:15], v[236:239], v[56:59], v[0:15]
    v_mfma_f32_32x32x16_bf16 v[16:31], v[240:243], v[56:59], v[16:31]
    buffer_load_dwordx4 v[80:83], v224, s[48:51], s77 offen sc1
    s_add_u32 s77, s77, 8192
    s_cmp_eq_u32 s77, 180224
    s_cselect_b32 s77, 0, s77
    ds_read_b64_tr_b16 v[228:229], v120 offset:8192
    ds_read_b64_tr_b16 v[230:231], v120 offset:9216
    ds_read_b64_tr_b16 v[232:233], v123 offset:8192
    ds_read_b64_tr_b16 v[234:235], v123 offset:9216
    s_waitcnt vmcnt(6) lgkmcnt(4)
    v_mfma_f32_32x32x16_bf16 v[0:15], v[244:247], v[60:63], v[0:15]
    v_mfma_f32_32x32x16_bf16 v[16:31], v[248:251], v[60:63], v[16:31]
    buffer_load_dwordx4 v[84:87], v224, s[48:51], s77 offen sc1
    s_add_u32 s77, s77, 8192
    s_cmp_eq_u32 s77, 180224
    s_cselect_b32 s77, 0, s77
    ds_read_b64_tr_b16 v[236:237], v120 offset:49152
    ds_read_b64_tr_b16 v[238:239], v120 offset:50176
    ds_read_b64_tr_b16 v[240:241], v123 offset:49152
    ds_read_b64_tr_b16 v[242:243], v123 offset:50176
    s_waitcnt vmcnt(5) lgkmcnt(4)
    v_mfma_f32_32x32x16_bf16 v[0:15], v[228:231], v[64:67], v[0:15]
    v_mfma_f32_32x32x16_bf16 v[16:31], v[232:235], v[64:67], v[16:31]
    buffer_load_dwordx4 v[88:91], v224, s[48:51], s77 offen sc1
    s_add_u32 s77, s77, 8192
    s_cmp_eq_u32 s77, 180224
    s_cselect_b32 s77, 0, s77
    ds_read_b64_tr_b16 v[244:245], v120 offset:57344
    ds_read_b64_tr_b16 v[246:247], v120 offset:58368
    ds_read_b64_tr_b16 v[248:249], v123 offset:57344
    ds_read_b64_tr_b16 v[250:251], v123 offset:58368
    s_waitcnt vmcnt(5) lgkmcnt(4)
    v_mfma_f32_32x32x16_bf16 v[0:15], v[236:239], v[68:71], v[0:15]
    v_mfma_f32_32x32x16_bf16 v[16:31], v[240:243], v[68:71], v[16:31]
    buffer_load_dwordx4 v[92:95], v224, s[48:51], s77 offen sc1
    s_add_u32 s77, s77, 8192
    s_cmp_eq_u32 s77, 180224
    s_cselect_b32 s77, 0, s77
    v_permlane32_swap_b32 v192, v194
    v_permlane32_swap_b32 v193, v195
    s_mov_b32 s36, 0xbfb8aa3b
    s_nop 0
    v_lshlrev_b32 v196, 16, v192
    v_and_b32 v197, 0xffff0000, v192
    v_lshlrev_b32 v198, 16, v193
    v_and_b32 v199, 0xffff0000, v193
    v_lshlrev_b32 v216, 16, v194
    v_and_b32 v217, 0xffff0000, v194
    v_lshlrev_b32 v218, 16, v195
    v_and_b32 v219, 0xffff0000, v195
    ds_read_b64_tr_b16 v[228:229], v121 offset:0
    ds_read_b64_tr_b16 v[230:231], v121 offset:1024
    ds_read_b64_tr_b16 v[232:233], v124 offset:0
    ds_read_b64_tr_b16 v[234:235], v124 offset:1024
    s_waitcnt vmcnt(5) lgkmcnt(4)
    v_mfma_f32_32x32x16_bf16 v[0:15], v[244:247], v[72:75], v[0:15]
    v_mfma_f32_32x32x16_bf16 v[16:31], v[248:251], v[72:75], v[16:31]
    buffer_load_dwordx4 v[96:99], v224, s[48:51], s77 offen sc1
    s_add_u32 s77, s77, 8192
    s_cmp_eq_u32 s77, 180224
    s_cselect_b32 s77, 0, s77
    ds_read_b64_tr_b16 v[236:237], v121 offset:8192
    ds_read_b64_tr_b16 v[238:239], v121 offset:9216
    ds_read_b64_tr_b16 v[240:241], v124 offset:8192
    ds_read_b64_tr_b16 v[242:243], v124 offset:9216
    s_waitcnt vmcnt(5) lgkmcnt(4)
    v_mfma_f32_32x32x16_bf16 v[0:15], v[228:231], v[76:79], v[0:15]
    v_mfma_f32_32x32x16_bf16 v[16:31], v[232:235], v[76:79], v[16:31]
    buffer_load_dwordx4 v[100:103], v224, s[48:51], s77 offen sc1
    s_add_u32 s77, s77, 8192
    s_cmp_eq_u32 s77, 180224
    s_cselect_b32 s77, 0, s77
    ds_read_b64_tr_b16 v[244:245], v120 offset:16384
    ds_read_b64_tr_b16 v[246:247], v120 offset:17408
    ds_read_b64_tr_b16 v[248:249], v123 offset:16384
    ds_read_b64_tr_b16 v[250:251], v123 offset:17408
    s_waitcnt vmcnt(5) lgkmcnt(4)
    v_mfma_f32_32x32x16_bf16 v[0:15], v[236:239], v[80:83], v[0:15]
    v_mfma_f32_32x32x16_bf16 v[16:31], v[240:243], v[80:83], v[16:31]
    buffer_load_dwordx4 v[32:35], v224, s[48:51], s77 offen sc1
    s_add_u32 s77, s77, 8192
    s_cmp_eq_u32 s77, 180224
    s_cselect_b32 s77, 0, s77
    ds_read_b64_tr_b16 v[228:229], v120 offset:24576
    ds_read_b64_tr_b16 v[230:231], v120 offset:25600
    ds_read_b64_tr_b16 v[232:233], v123 offset:24576
    ds_read_b64_tr_b16 v[234:235], v123 offset:25600
    s_waitcnt vmcnt(5) lgkmcnt(4)
    v_mfma_f32_32x32x16_bf16 v[0:15], v[244:247], v[84:87], v[0:15]
    v_mfma_f32_32x32x16_bf16 v[16:31], v[248:251], v[84:87], v[16:31]
    buffer_load_dwordx4 v[36:39], v224, s[48:51], s77 offen sc1
    s_add_u32 s77, s77, 8192
    s_cmp_eq_u32 s77, 180224
    s_cselect_b32 s77, 0, s77
    s_barrier
    ds_read_b64_tr_b16 v[236:237], v121 offset:16384
    ds_read_b64_tr_b16 v[238:239], v121 offset:17408
    ds_read_b64_tr_b16 v[240:241], v124 offset:16384
    ds_read_b64_tr_b16 v[242:243], v124 offset:17408
    s_waitcnt vmcnt(5) lgkmcnt(4)
    v_mfma_f32_32x32x16_bf16 v[0:15], v[228:231], v[88:91], v[0:15]
    v_mfma_f32_32x32x16_bf16 v[16:31], v[232:235], v[88:91], v[16:31]
    buffer_load_dwordx4 v[40:43], v224, s[48:51], s77 offen sc1
    s_add_u32 s77, s77, 8192
    s_cmp_eq_u32 s77, 180224
    s_cselect_b32 s77, 0, s77
    ds_read_b64_tr_b16 v[244:245], v121 offset:24576
    ds_read_b64_tr_b16 v[246:247], v121 offset:25600
    ds_read_b64_tr_b16 v[248:249], v124 offset:24576
    ds_read_b64_tr_b16 v[250:251], v124 offset:25600
    s_waitcnt vmcnt(5) lgkmcnt(4)
    v_mfma_f32_32x32x16_bf16 v[0:15], v[236:239], v[92:95], v[0:15]
    v_mfma_f32_32x32x16_bf16 v[16:31], v[240:243], v[92:95], v[16:31]
    buffer_load_dwordx4 v[44:47], v224, s[48:51], s77 offen sc1
    s_add_u32 s77, s77, 8192
    s_cmp_eq_u32 s77, 180224
    s_cselect_b32 s77, 0, s77
    s_mov_b32 s21, 0
    s_waitcnt vmcnt(6)
p2_v1:
    v_cmp_ne_u64 vcc, v[252:253], v[226:227]
    s_add_u32 s21, s21, 1
    s_nop 3
    s_cbranch_vccz p2_v2
    s_cmp_lt_u32 s21, 65536
    s_cbranch_scc0 p2_v2
    s_sleep 4
    buffer_load_dwordx2 v[252:253], v126, s[56:59], s39 offen sc1
    s_waitcnt vmcnt(0)
    s_branch p2_v1
p2_v2:
    buffer_load_dwordx4 v[160:163], v206, s[56:59], s37 offen sc1
    s_add_u32 s37, s37, 9216
    buffer_load_dwordx4 v[164:167], v206, s[56:59], s37 offen sc1
    s_add_u32 s37, s37, 9216
    buffer_load_dwordx4 v[168:171], v206, s[56:59], s37 offen sc1
    s_add_u32 s37, s37, 9216
    buffer_load_dwordx4 v[172:175], v206, s[56:59], s37 offen sc1
    s_add_u32 s37, s37, 9216
    buffer_load_dwordx4 v[176:179], v206, s[56:59], s37 offen sc1
    s_add_u32 s37, s37, 9216
    buffer_load_dwordx4 v[180:183], v206, s[56:59], s37 offen sc1
    s_add_u32 s37, s37, 9216
    buffer_load_dwordx4 v[184:187], v206, s[56:59], s37 offen sc1
    s_add_u32 s37, s37, 9216
    buffer_load_dwordx4 v[188:191], v206, s[56:59], s37 offen sc1
    ds_read_b64_tr_b16 v[228:229], v121 offset:32768
    ds_read_b64_tr_b16 v[230:231], v121 offset:33792
    ds_read_b64_tr_b16 v[232:233], v124 offset:32768
    ds_read_b64_tr_b16 v[234:235], v124 offset:33792
    s_waitcnt vmcnt(13) lgkmcnt(4)
    v_mfma_f32_32x32x16_bf16 v[0:15], v[244:247], v[96:99], v[0:15]
    v_mfma_f32_32x32x16_bf16 v[16:31], v[248:251], v[96:99], v[16:31]
    ds_read_b64_tr_b16 v[236:237], v121 offset:40960
    ds_read_b64_tr_b16 v[238:239], v121 offset:41984
    ds_read_b64_tr_b16 v[240:241], v124 offset:40960
    ds_read_b64_tr_b16 v[242:243], v124 offset:41984
    s_waitcnt vmcnt(12) lgkmcnt(4)
    v_mfma_f32_32x32x16_bf16 v[0:15], v[228:231], v[100:103], v[0:15]
    v_mfma_f32_32x32x16_bf16 v[16:31], v[232:235], v[100:103], v[16:31]
    ds_read_b64_tr_b16 v[244:245], v122 offset:24576
    ds_read_b64_tr_b16 v[246:247], v122 offset:25600
    ds_read_b64_tr_b16 v[248:249], v125 offset:24576
    ds_read_b64_tr_b16 v[250:251], v125 offset:25600
    s_waitcnt vmcnt(11) lgkmcnt(4)
    v_mfma_f32_32x32x16_bf16 v[0:15], v[236:239], v[32:35], v[0:15]
    v_mfma_f32_32x32x16_bf16 v[16:31], v[240:243], v[32:35], v[16:31]
    ds_read_b64_tr_b16 v[228:229], v120 offset:32768
    ds_read_b64_tr_b16 v[230:231], v120 offset:33792
    ds_read_b64_tr_b16 v[232:233], v123 offset:32768
    ds_read_b64_tr_b16 v[234:235], v123 offset:33792
    s_waitcnt vmcnt(10) lgkmcnt(4)
    v_mfma_f32_32x32x16_bf16 v[0:15], v[244:247], v[36:39], v[0:15]
    v_mfma_f32_32x32x16_bf16 v[16:31], v[248:251], v[36:39], v[16:31]
    ds_read_b64_tr_b16 v[236:237], v120 offset:40960
    ds_read_b64_tr_b16 v[238:239], v120 offset:41984
    ds_read_b64_tr_b16 v[240:241], v123 offset:40960
    ds_read_b64_tr_b16 v[242:243], v123 offset:41984
    s_waitcnt vmcnt(9) lgkmcnt(4)
    v_mfma_f32_32x32x16_bf16 v[0:15], v[228:231], v[40:43], v[0:15]
    v_mfma_f32_32x32x16_bf16 v[16:31], v[232:235], v[40:43], v[16:31]
    s_waitcnt vmcnt(8) lgkmcnt(0)
    v_mfma_f32_32x32x16_bf16 v[0:15], v[236:239], v[44:47], v[0:15]
    v_mfma_f32_32x32x16_bf16 v[16:31], v[240:243], v[44:47], v[16:31]
    s_nop 7
    s_nop 1
    s_cmp_eq_u32 s72, 0
    s_cbranch_scc0 p2_b_e1
    ds_write_b128 v211, v[0:3] offset:0
    ds_write_b128 v211, v[4:7] offset:1024
    ds_write_b128 v211, v[16:19] offset:16384
    ds_write_b128 v211, v[20:23] offset:17408
    ds_write_b128 v211, v[24:27] offset:24576
    ds_write_b128 v211, v[28:31] offset:25600
    s_waitcnt vmcnt(0)
    v_mfma_f32_32x32x16_bf16 v[104:119], v[160:163], v[128:131], 0
    v_mfma_f32_32x32x16_bf16 v[104:119], v[164:167], v[132:135], v[104:119]
    v_mfma_f32_32x32x16_bf16 v[104:119], v[168:171], v[136:139], v[104:119]
    v_mfma_f32_32x32x16_bf16 v[104:119], v[172:175], v[140:143], v[104:119]
    v_mfma_f32_32x32x16_bf16 v[104:119], v[176:179], v[144:147], v[104:119]
    v_mfma_f32_32x32x16_bf16 v[104:119], v[180:183], v[148:151], v[104:119]
    v_mfma_f32_32x32x16_bf16 v[104:119], v[184:187], v[152:155], v[104:119]
    v_mfma_f32_32x32x16_bf16 v[104:119], v[188:191], v[156:159], v[104:119]
    s_nop 7
    s_nop 3
    ds_write_b128 v212, v[104:107] offset:2048
    ds_write_b128 v212, v[108:111] offset:3072
    s_waitcnt lgkmcnt(0)
    s_barrier
    ds_read_b128 v[32:35], v212 offset:0
    ds_read_b128 v[36:39], v212 offset:1024
    ds_read_b128 v[40:43], v212 offset:4096
    ds_read_b128 v[44:47], v212 offset:5120
    ds_read_b128 v[48:51], v212 offset:6144
    ds_read_b128 v[52:55], v212 offset:7168
    s_waitcnt lgkmcnt(4)
    v_pk_add_f32 v[72:73], v[8:9], v[32:33]
    v_pk_add_f32 v[74:75], v[10:11], v[34:35]
    v_pk_add_f32 v[76:77], v[12:13], v[36:37]
    v_pk_add_f32 v[78:79], v[14:15], v[38:39]
    s_branch p2_b_e2
p2_b_e1:
    ds_write_b128 v211, v[0:3] offset:0
    ds_write_b128 v211, v[4:7] offset:1024
    ds_write_b128 v211, v[8:11] offset:8192
    ds_write_b128 v211, v[12:15] offset:9216
    ds_write_b128 v211, v[16:19] offset:16384
    ds_write_b128 v211, v[20:23] offset:17408
    s_waitcnt vmcnt(0)
    v_mfma_f32_32x32x16_bf16 v[104:119], v[160:163], v[128:131], 0
    v_mfma_f32_32x32x16_bf16 v[104:119], v[164:167], v[132:135], v[104:119]
    v_mfma_f32_32x32x16_bf16 v[104:119], v[168:171], v[136:139], v[104:119]
    v_mfma_f32_32x32x16_bf16 v[104:119], v[172:175], v[140:143], v[104:119]
    v_mfma_f32_32x32x16_bf16 v[104:119], v[176:179], v[144:147], v[104:119]
    v_mfma_f32_32x32x16_bf16 v[104:119], v[180:183], v[148:151], v[104:119]
    v_mfma_f32_32x32x16_bf16 v[104:119], v[184:187], v[152:155], v[104:119]
    v_mfma_f32_32x32x16_bf16 v[104:119], v[188:191], v[156:159], v[104:119]
    s_nop 7
    s_nop 3
    ds_write_b128 v212, v[104:107] offset:6144
    ds_write_b128 v212, v[108:111] offset:7168
    s_waitcnt lgkmcnt(0)
    s_barrier
    ds_read_b128 v[32:35], v212 offset:0
    ds_read_b128 v[36:39], v212 offset:1024
    ds_read_b128 v[40:43], v212 offset:2048
    ds_read_b128 v[44:47], v212 offset:3072
    ds_read_b128 v[48:51], v212 offset:4096
    ds_read_b128 v[52:55], v212 offset:5120
    s_waitcnt lgkmcnt(4)
    v_pk_add_f32 v[72:73], v[24:25], v[32:33]
    v_pk_add_f32 v[74:75], v[26:27], v[34:35]
    v_pk_add_f32 v[76:77], v[28:29], v[36:37]
    v_pk_add_f32 v[78:79], v[30:31], v[38:39]
p2_b_e2:
    s_waitcnt lgkmcnt(0)
    v_pk_add_f32 v[40:41], v[40:41], v[48:49]
    v_pk_add_f32 v[42:43], v[42:43], v[50:51]
    v_pk_add_f32 v[44:45], v[44:45], v[52:53]
    v_pk_add_f32 v[46:47], v[46:47], v[54:55]
    v_pk_add_f32 v[72:73], v[72:73], v[40:41]
    v_pk_add_f32 v[74:75], v[74:75], v[42:43]
    v_pk_add_f32 v[76:77], v[76:77], v[44:45]
    v_pk_add_f32 v[78:79], v[78:79], v[46:47]
    v_mul_f32 v32, s36, v72
    v_mul_f32 v33, s36, v73
    v_mul_f32 v34, s36, v74
    v_mul_f32 v35, s36, v75
    v_mul_f32 v36, s36, v76
    v_mul_f32 v37, s36, v77
    v_mul_f32 v38, s36, v78
    v_mul_f32 v39, s36, v79
    v_exp_f32 v32, v32
    v_exp_f32 v33, v33
    v_exp_f32 v34, v34
    v_exp_f32 v35, v35
    v_exp_f32 v36, v36
    v_exp_f32 v37, v37
    v_exp_f32 v38, v38
    v_exp_f32 v39, v39
    v_pk_mul_f32 v[72:73], v[72:73], v[112:113]
    v_pk_mul_f32 v[74:75], v[74:75], v[114:115]
    v_pk_mul_f32 v[76:77], v[76:77], v[116:117]
    v_pk_mul_f32 v[78:79], v[78:79], v[118:119]
    v_pk_add_f32 v[32:33], v[32:33], 1.0 op_sel_hi:[1,0]
    v_pk_add_f32 v[34:35], v[34:35], 1.0 op_sel_hi:[1,0]
    v_pk_add_f32 v[36:37], v[36:37], 1.0 op_sel_hi:[1,0]
    v_pk_add_f32 v[38:39], v[38:39], 1.0 op_sel_hi:[1,0]
    v_rcp_f32 v32, v32
    v_rcp_f32 v33, v33
    v_rcp_f32 v34, v34
    v_rcp_f32 v35, v35
    v_rcp_f32 v36, v36
    v_rcp_f32 v37, v37
    v_rcp_f32 v38, v38
    v_rcp_f32 v39, v39
    s_nop 0
    v_pk_fma_f32 v[72:73], v[72:73], v[32:33], v[196:197]
    v_pk_fma_f32 v[74:75], v[74:75], v[34:35], v[198:199]
    v_pk_fma_f32 v[76:77], v[76:77], v[36:37], v[216:217]
    v_pk_fma_f32 v[78:79], v[78:79], v[38:39], v[218:219]
    v_cvt_pk_bf16_f32 v192, v72, v73
    v_cvt_pk_bf16_f32 v193, v74, v75
    v_cvt_pk_bf16_f32 v194, v76, v77
    v_cvt_pk_bf16_f32 v195, v78, v79
    s_nop 1
    v_permlane32_swap_b32 v192, v194
    v_permlane32_swap_b32 v193, v195
    ds_write_b128 v213, v[192:195]
    s_waitcnt lgkmcnt(0)
    s_barrier
    ds_read_b128 v[192:195], v214
    s_waitcnt lgkmcnt(0)
    buffer_store_dwordx4 v[192:195], v215, s[44:47], s38 offen sc1
    s_endpgm
ld:
    s_mov_b64 s[6:7], s[70:71]
    s_and_b32 s52, s2, 7
    s_lshr_b32 s53, s2, 3
    s_and_b32 s70, s52, 7
    s_lshl_b32 s70, s70, 2
    s_and_b32 s23, s53, 3
    s_add_u32 s70, s70, s23
    s_lshr_b32 s71, s52, 3
    s_lshl_b32 s71, s71, 3
    s_lshr_b32 s23, s53, 2
    s_add_u32 s71, s71, s23
    s_mul_i32 s77, s71, 11
    s_mul_i32 s23, s70, 2
    s_add_u32 s77, s77, s23
    s_mul_i32 s23, s77, 2979
    s_lshr_b32 s23, s23, 16
    s_mul_i32 s23, s23, 22
    s_sub_u32 s77, s77, s23
    s_mov_b32 s74, s77
    s_and_b32 s72, s3, 1
    s_bfe_u32 s73, s3, 0x10001
    s_lshl_b32 s76, s73, 20
    s_lshl_b32 s23, s70, 10
    s_add_u32 s76, s76, s23
    s_lshl_b32 s23, s71, 7
    s_add_u32 s76, s76, s23
    s_lshl_b32 s23, s72, 6
    s_add_u32 s76, s76, s23
    s_mov_b32 s56, s6
    s_and_b32 s57, s7, 0xffff
    s_mov_b32 s58, 0x10000000
    s_mov_b32 s59, 0x00020000
    s_mov_b32 s60, s68
    s_and_b32 s61, s69, 0xffff
    s_mov_b32 s62, 0x100
    s_mov_b32 s63, 0x00020000
    s_mov_b32 s32, s64
    s_and_b32 s33, s65, 0xffff
    s_mov_b32 s34, 0x158000
    s_mov_b32 s35, 0x00020000
    s_mov_b32 s44, s66
    s_and_b32 s45, s67, 0xffff
    s_mov_b32 s46, 0x200000
    s_mov_b32 s47, 0x00020000
    v_mov_b32 v98, 0
    v_mov_b32 v93, 161616
    ds_write_b32 v93, v98
    v_lshrrev_b32 v204, 3, v200
    v_and_b32 v205, 7, v200
    v_bfe_u32 v206, v200, 4, 1
    v_lshlrev_b32 v206, 2, v206
    v_xor_b32 v205, v205, v206
    v_lshlrev_b32 v204, 10, v204
    v_lshl_add_u32 v220, v205, 4, v204
    v_add_u32 v221, 7168, v220
    v_add_u32 v222, 14336, v220
    v_add_u32 v223, 21504, v220
    v_and_b32 v204, 31, v200
    v_lshrrev_b32 v205, 5, v200
    s_cmp_lt_u32 s71, 4
    s_cselect_b32 s38, 0, 0x80000000
    s_lshl_b32 s21, s73, 10
    s_add_u32 s21, s21, s70
    v_lshl_add_u32 v209, v204, 5, s21
    v_lshlrev_b32 v210, 2, v205
    v_mul_u32_u24 v210, v210, v209
    s_mov_b32 s42, 0x3a000000
    v_mov_b32 v90, v209
    v_mov_b32 v91, v210
    v_lshlrev_b32 v225, 15, v204
    v_lshl_add_u32 v225, v205, 4, v225
    s_mov_b32 s39, s49
    s_mul_i32 s23, s39, 6144
    s_add_u32 s23, s23, 49152
    s_and_b32 s21, s18, 1
    s_mul_i32 s21, s21, 14464
    s_add_u32 s23, s23, s21
    s_lshr_b32 s21, s18, 1
    s_lshl_b32 s21, s21, 6
    s_add_u32 s23, s23, s21
    v_lshrrev_b32 v205, 5, v200
    v_bfe_u32 v206, v200, 2, 2
    v_lshl_add_u32 v206, v205, 3, v206
    v_mul_u32_u24 v206, 192, v206
    v_and_b32 v207, 3, v200
    v_lshl_add_u32 v206, v207, 3, v206
    v_bfe_u32 v207, v200, 4, 1
    v_mul_u32_u24 v207, 32, v207
    v_add3_u32 v112, v206, v207, s23
    s_add_u32 s21, s40, s48
    s_lshl_b32 s21, s21, 1
    s_add_u32 s39, s39, s21
    s_lshl_b32 s21, s17, 4
    s_add_u32 s39, s39, s21
    s_lshl_b32 s39, s39, 10
    s_lshl_b32 s21, s18, 7
    s_add_u32 s39, s39, s21
    s_add_u32 s39, s39, 0x910000
    s_mov_b32 s43, 0x3f803f80
    v_lshlrev_b32 v97, 2, v200
    v_mad_u32_u24 v4, v90, 0, v91
    v_mad_u32_u24 v5, v90, 1, v91
    v_mad_u32_u24 v6, v90, 2, v91
    v_mad_u32_u24 v7, v90, 3, v91
    v_and_b32 v4, 0x7ff, v4
    v_and_b32 v5, 0x7ff, v5
    v_and_b32 v6, 0x7ff, v6
    v_and_b32 v7, 0x7ff, v7
    v_cvt_f32_u32 v4, v4
    v_cvt_f32_u32 v5, v5
    v_cvt_f32_u32 v6, v6
    v_cvt_f32_u32 v7, v7
    v_mul_f32 v4, s42, v4
    v_mul_f32 v5, s42, v5
    v_mul_f32 v6, s42, v6
    v_mul_f32 v7, s42, v7
    v_cos_f32 v8, v4
    v_cos_f32 v9, v5
    v_cos_f32 v10, v6
    v_cos_f32 v11, v7
    v_sin_f32 v4, v4
    v_sin_f32 v5, v5
    v_sin_f32 v6, v6
    v_sin_f32 v7, v7
    v_cvt_pk_bf16_f32 v8, v8, v4
    v_cvt_pk_bf16_f32 v9, v9, v5
    v_cvt_pk_bf16_f32 v10, v10, v6
    v_cvt_pk_bf16_f32 v11, v11, v7
    v_xor_b32 v128, s38, v8
    v_xor_b32 v129, s38, v9
    v_xor_b32 v130, s38, v10
    v_xor_b32 v131, s38, v11
    v_mad_u32_u24 v4, v90, 8, v91
    v_mad_u32_u24 v5, v90, 9, v91
    v_mad_u32_u24 v6, v90, 10, v91
    v_mad_u32_u24 v7, v90, 11, v91
    v_and_b32 v4, 0x7ff, v4
    v_and_b32 v5, 0x7ff, v5
    v_and_b32 v6, 0x7ff, v6
    v_and_b32 v7, 0x7ff, v7
    v_cvt_f32_u32 v4, v4
    v_cvt_f32_u32 v5, v5
    v_cvt_f32_u32 v6, v6
    v_cvt_f32_u32 v7, v7
    v_mul_f32 v4, s42, v4
    v_mul_f32 v5, s42, v5
    v_mul_f32 v6, s42, v6
    v_mul_f32 v7, s42, v7
    v_cos_f32 v8, v4
    v_cos_f32 v9, v5
    v_cos_f32 v10, v6
    v_cos_f32 v11, v7
    v_sin_f32 v4, v4
    v_sin_f32 v5, v5
    v_sin_f32 v6, v6
    v_sin_f32 v7, v7
    v_cvt_pk_bf16_f32 v8, v8, v4
    v_cvt_pk_bf16_f32 v9, v9, v5
    v_cvt_pk_bf16_f32 v10, v10, v6
    v_cvt_pk_bf16_f32 v11, v11, v7
    v_xor_b32 v132, s38, v8
    v_xor_b32 v133, s38, v9
    v_xor_b32 v134, s38, v10
    v_xor_b32 v135, s38, v11
    v_mad_u32_u24 v4, v90, 16, v91
    v_mad_u32_u24 v5, v90, 17, v91
    v_mad_u32_u24 v6, v90, 18, v91
    v_mad_u32_u24 v7, v90, 19, v91
    v_and_b32 v4, 0x7ff, v4
    v_and_b32 v5, 0x7ff, v5
    v_and_b32 v6, 0x7ff, v6
    v_and_b32 v7, 0x7ff, v7
    v_cvt_f32_u32 v4, v4
    v_cvt_f32_u32 v5, v5
    v_cvt_f32_u32 v6, v6
    v_cvt_f32_u32 v7, v7
    v_mul_f32 v4, s42, v4
    v_mul_f32 v5, s42, v5
    v_mul_f32 v6, s42, v6
    v_mul_f32 v7, s42, v7
    v_cos_f32 v8, v4
    v_cos_f32 v9, v5
    v_cos_f32 v10, v6
    v_cos_f32 v11, v7
    v_sin_f32 v4, v4
    v_sin_f32 v5, v5
    v_sin_f32 v6, v6
    v_sin_f32 v7, v7
    v_cvt_pk_bf16_f32 v8, v8, v4
    v_cvt_pk_bf16_f32 v9, v9, v5
    v_cvt_pk_bf16_f32 v10, v10, v6
    v_cvt_pk_bf16_f32 v11, v11, v7
    v_xor_b32 v136, s38, v8
    v_xor_b32 v137, s38, v9
    v_xor_b32 v138, s38, v10
    v_xor_b32 v139, s38, v11
    v_mad_u32_u24 v4, v90, 24, v91
    v_mad_u32_u24 v5, v90, 25, v91
    v_mad_u32_u24 v6, v90, 26, v91
    v_mad_u32_u24 v7, v90, 27, v91
    v_and_b32 v4, 0x7ff, v4
    v_and_b32 v5, 0x7ff, v5
    v_and_b32 v6, 0x7ff, v6
    v_and_b32 v7, 0x7ff, v7
    v_cvt_f32_u32 v4, v4
    v_cvt_f32_u32 v5, v5
    v_cvt_f32_u32 v6, v6
    v_cvt_f32_u32 v7, v7
    v_mul_f32 v4, s42, v4
    v_mul_f32 v5, s42, v5
    v_mul_f32 v6, s42, v6
    v_mul_f32 v7, s42, v7
    v_cos_f32 v8, v4
    v_cos_f32 v9, v5
    v_cos_f32 v10, v6
    v_cos_f32 v11, v7
    v_sin_f32 v4, v4
    v_sin_f32 v5, v5
    v_sin_f32 v6, v6
    v_sin_f32 v7, v7
    v_cvt_pk_bf16_f32 v8, v8, v4
    v_cvt_pk_bf16_f32 v9, v9, v5
    v_cvt_pk_bf16_f32 v10, v10, v6
    v_cvt_pk_bf16_f32 v11, v11, v7
    v_xor_b32 v140, s38, v8
    v_xor_b32 v141, s38, v9
    v_xor_b32 v142, s38, v10
    v_xor_b32 v143, s38, v11
    v_mad_u32_u24 v4, v90, 32, v91
    v_mad_u32_u24 v5, v90, 33, v91
    v_mad_u32_u24 v6, v90, 34, v91
    v_mad_u32_u24 v7, v90, 35, v91
    v_and_b32 v4, 0x7ff, v4
    v_and_b32 v5, 0x7ff, v5
    v_and_b32 v6, 0x7ff, v6
    v_and_b32 v7, 0x7ff, v7
    v_cvt_f32_u32 v4, v4
    v_cvt_f32_u32 v5, v5
    v_cvt_f32_u32 v6, v6
    v_cvt_f32_u32 v7, v7
    v_mul_f32 v4, s42, v4
    v_mul_f32 v5, s42, v5
    v_mul_f32 v6, s42, v6
    v_mul_f32 v7, s42, v7
    v_cos_f32 v8, v4
    v_cos_f32 v9, v5
    v_cos_f32 v10, v6
    v_cos_f32 v11, v7
    v_sin_f32 v4, v4
    v_sin_f32 v5, v5
    v_sin_f32 v6, v6
    v_sin_f32 v7, v7
    v_cvt_pk_bf16_f32 v8, v8, v4
    v_cvt_pk_bf16_f32 v9, v9, v5
    v_cvt_pk_bf16_f32 v10, v10, v6
    v_cvt_pk_bf16_f32 v11, v11, v7
    v_xor_b32 v144, s38, v8
    v_xor_b32 v145, s38, v9
    v_xor_b32 v146, s38, v10
    v_xor_b32 v147, s38, v11
    v_mad_u32_u24 v4, v90, 40, v91
    v_mad_u32_u24 v5, v90, 41, v91
    v_mad_u32_u24 v6, v90, 42, v91
    v_mad_u32_u24 v7, v90, 43, v91
    v_and_b32 v4, 0x7ff, v4
    v_and_b32 v5, 0x7ff, v5
    v_and_b32 v6, 0x7ff, v6
    v_and_b32 v7, 0x7ff, v7
    v_cvt_f32_u32 v4, v4
    v_cvt_f32_u32 v5, v5
    v_cvt_f32_u32 v6, v6
    v_cvt_f32_u32 v7, v7
    v_mul_f32 v4, s42, v4
    v_mul_f32 v5, s42, v5
    v_mul_f32 v6, s42, v6
    v_mul_f32 v7, s42, v7
    v_cos_f32 v8, v4
    v_cos_f32 v9, v5
    v_cos_f32 v10, v6
    v_cos_f32 v11, v7
    v_sin_f32 v4, v4
    v_sin_f32 v5, v5
    v_sin_f32 v6, v6
    v_sin_f32 v7, v7
    v_cvt_pk_bf16_f32 v8, v8, v4
    v_cvt_pk_bf16_f32 v9, v9, v5
    v_cvt_pk_bf16_f32 v10, v10, v6
    v_cvt_pk_bf16_f32 v11, v11, v7
    v_xor_b32 v148, s38, v8
    v_xor_b32 v149, s38, v9
    v_xor_b32 v150, s38, v10
    v_xor_b32 v151, s38, v11
    v_mad_u32_u24 v4, v90, 48, v91
    v_mad_u32_u24 v5, v90, 49, v91
    v_mad_u32_u24 v6, v90, 50, v91
    v_mad_u32_u24 v7, v90, 51, v91
    v_and_b32 v4, 0x7ff, v4
    v_and_b32 v5, 0x7ff, v5
    v_and_b32 v6, 0x7ff, v6
    v_and_b32 v7, 0x7ff, v7
    v_cvt_f32_u32 v4, v4
    v_cvt_f32_u32 v5, v5
    v_cvt_f32_u32 v6, v6
    v_cvt_f32_u32 v7, v7
    v_mul_f32 v4, s42, v4
    v_mul_f32 v5, s42, v5
    v_mul_f32 v6, s42, v6
    v_mul_f32 v7, s42, v7
    v_cos_f32 v8, v4
    v_cos_f32 v9, v5
    v_cos_f32 v10, v6
    v_cos_f32 v11, v7
    v_sin_f32 v4, v4
    v_sin_f32 v5, v5
    v_sin_f32 v6, v6
    v_sin_f32 v7, v7
    v_cvt_pk_bf16_f32 v8, v8, v4
    v_cvt_pk_bf16_f32 v9, v9, v5
    v_cvt_pk_bf16_f32 v10, v10, v6
    v_cvt_pk_bf16_f32 v11, v11, v7
    v_xor_b32 v152, s38, v8
    v_xor_b32 v153, s38, v9
    v_xor_b32 v154, s38, v10
    v_xor_b32 v155, s38, v11
    v_mad_u32_u24 v4, v90, 56, v91
    v_mad_u32_u24 v5, v90, 57, v91
    v_mad_u32_u24 v6, v90, 58, v91
    v_mad_u32_u24 v7, v90, 59, v91
    v_and_b32 v4, 0x7ff, v4
    v_and_b32 v5, 0x7ff, v5
    v_and_b32 v6, 0x7ff, v6
    v_and_b32 v7, 0x7ff, v7
    v_cvt_f32_u32 v4, v4
    v_cvt_f32_u32 v5, v5
    v_cvt_f32_u32 v6, v6
    v_cvt_f32_u32 v7, v7
    v_mul_f32 v4, s42, v4
    v_mul_f32 v5, s42, v5
    v_mul_f32 v6, s42, v6
    v_mul_f32 v7, s42, v7
    v_cos_f32 v8, v4
    v_cos_f32 v9, v5
    v_cos_f32 v10, v6
    v_cos_f32 v11, v7
    v_sin_f32 v4, v4
    v_sin_f32 v5, v5
    v_sin_f32 v6, v6
    v_sin_f32 v7, v7
    v_cvt_pk_bf16_f32 v8, v8, v4
    v_cvt_pk_bf16_f32 v9, v9, v5
    v_cvt_pk_bf16_f32 v10, v10, v6
    v_cvt_pk_bf16_f32 v11, v11, v7
    v_xor_b32 v156, s38, v8
    v_xor_b32 v157, s38, v9
    v_xor_b32 v158, s38, v10
    v_xor_b32 v159, s38, v11
    s_lshl_b32 s52, s41, 7
    s_add_u32 s52, s52, s20
    s_add_u32 m0, s22, 16384
    s_mul_i32 s53, s41, 65536
    buffer_load_dwordx4 v100, s[24:27], s52 offen offset:0 lds
    buffer_load_dwordx4 v101, s[24:27], s52 offen offset:1024 lds
    buffer_load_dwordx4 v102, s[24:27], s52 offen offset:2048 lds
    buffer_load_dwordx4 v103, s[24:27], s52 offen offset:3072 lds
    s_add_u32 s53, s53, s36
    s_add_u32 m0, s37, 32768
    s_nop 0
    buffer_load_dwordx4 v104, s[28:31], s53 offen offset:0 lds
    buffer_load_dwordx4 v105, s[28:31], s53 offen offset:1024 lds
    buffer_load_dwordx4 v106, s[28:31], s53 offen offset:2048 lds
    buffer_load_dwordx4 v107, s[28:31], s53 offen offset:3072 lds
    s_add_u32 m0, s37, 36864
    s_nop 0
    buffer_load_dwordx4 v108, s[28:31], s53 offen offset:0 lds
    buffer_load_dwordx4 v109, s[28:31], s53 offen offset:1024 lds
    s_add_u32 s41, s41, 1
    s_and_b32 s41, s41, 7
    s_waitcnt vmcnt(10)
    s_barrier
    v_and_b32 v94, 3, v200
    v_lshlrev_b32 v94, 4, v94
    v_add_u32 v93, 161536, v94
    ds_read_b128 v[84:87], v93
    s_waitcnt lgkmcnt(0)
    s_cmp_eq_u32 s3, 4
    s_cbranch_scc0 ld_nr
    s_and_b32 s21, s2, 63
    s_lshl_b32 s21, s21, 8
    s_and_b32 s23, s2, 0xc0
    s_add_u32 s21, s21, s23
    s_add_u32 s21, s21, 0x900000
    s_mov_b64 exec, 15
    buffer_store_dwordx4 v[84:87], v94, s[56:59], s21 offen sc1
    s_mov_b64 exec, -1
ld_nr:
    s_cmp_eq_u32 s48, 0
    s_cbranch_scc0 ld_nc0
    ds_read_b64_tr_b16 v[64:65], v112 offset:0
    ds_read_b64_tr_b16 v[66:67], v112 offset:768
    ds_read_b64_tr_b16 v[68:69], v112 offset:3072
    ds_read_b64_tr_b16 v[70:71], v112 offset:3840
    ds_read_b64_tr_b16 v[72:73], v112 offset:128
    ds_read_b64_tr_b16 v[74:75], v112 offset:896
    ds_read_b64_tr_b16 v[76:77], v112 offset:3200
    ds_read_b64_tr_b16 v[78:79], v112 offset:3968
    v_mov_b32 v80, 0
    v_mov_b32 v81, 0
    s_waitcnt lgkmcnt(0)
    v_dot2c_f32_bf16 v80, s43, v64
    v_dot2c_f32_bf16 v81, s43, v72
    v_dot2c_f32_bf16 v80, s43, v65
    v_dot2c_f32_bf16 v81, s43, v73
    v_dot2c_f32_bf16 v80, s43, v66
    v_dot2c_f32_bf16 v81, s43, v74
    v_dot2c_f32_bf16 v80, s43, v67
    v_dot2c_f32_bf16 v81, s43, v75
    v_dot2c_f32_bf16 v80, s43, v68
    v_dot2c_f32_bf16 v81, s43, v76
    v_dot2c_f32_bf16 v80, s43, v69
    v_dot2c_f32_bf16 v81, s43, v77
    v_dot2c_f32_bf16 v80, s43, v70
    v_dot2c_f32_bf16 v81, s43, v78
    v_dot2c_f32_bf16 v80, s43, v71
    v_dot2c_f32_bf16 v81, s43, v79
    s_nop 2
    v_mov_b32 v82, v80
    v_mov_b32 v83, v81
    s_nop 1
    v_permlane32_swap_b32 v80, v82
    v_permlane32_swap_b32 v81, v83
    s_nop 1
    v_add_f32 v80, v80, v82
    v_add_f32 v81, v81, v83
    s_mov_b32 exec_hi, 0
    buffer_store_dword v80, v97, s[56:59], s39 offen offset:0 sc1
    buffer_store_dword v81, v97, s[56:59], s39 offen offset:512 sc1
    s_mov_b32 exec_hi, -1
ld_nc0:
    buffer_load_dwordx2 v[88:89], v98, s[60:63], 0 offen sc1
    s_lshl_b32 s52, s41, 7
    s_add_u32 s52, s52, s20
    s_add_u32 m0, s22, 32768
    s_mul_i32 s53, s41, 65536
    buffer_load_dwordx4 v100, s[24:27], s52 offen offset:0 lds
    buffer_load_dwordx4 v101, s[24:27], s52 offen offset:1024 lds
    buffer_load_dwordx4 v102, s[24:27], s52 offen offset:2048 lds
    buffer_load_dwordx4 v103, s[24:27], s52 offen offset:3072 lds
    s_add_u32 s53, s53, s36
    s_add_u32 m0, s37, 65536
    s_nop 0
    buffer_load_dwordx4 v104, s[28:31], s53 offen offset:0 lds
    buffer_load_dwordx4 v105, s[28:31], s53 offen offset:1024 lds
    buffer_load_dwordx4 v106, s[28:31], s53 offen offset:2048 lds
    buffer_load_dwordx4 v107, s[28:31], s53 offen offset:3072 lds
    s_add_u32 m0, s37, 69632
    s_nop 0
    buffer_load_dwordx4 v108, s[28:31], s53 offen offset:0 lds
    buffer_load_dwordx4 v109, s[28:31], s53 offen offset:1024 lds
    s_add_u32 s41, s41, 1
    s_and_b32 s41, s41, 7
    s_waitcnt vmcnt(11)
    s_barrier
    s_cmp_eq_u32 s48, 1
    s_cbranch_scc0 ld_nc1
    ds_read_b64_tr_b16 v[64:65], v112 offset:32768
    ds_read_b64_tr_b16 v[66:67], v112 offset:33536
    ds_read_b64_tr_b16 v[68:69], v112 offset:35840
    ds_read_b64_tr_b16 v[70:71], v112 offset:36608
    ds_read_b64_tr_b16 v[72:73], v112 offset:32896
    ds_read_b64_tr_b16 v[74:75], v112 offset:33664
    ds_read_b64_tr_b16 v[76:77], v112 offset:35968
    ds_read_b64_tr_b16 v[78:79], v112 offset:36736
    v_mov_b32 v80, 0
    v_mov_b32 v81, 0
    s_waitcnt lgkmcnt(0)
    v_dot2c_f32_bf16 v80, s43, v64
    v_dot2c_f32_bf16 v81, s43, v72
    v_dot2c_f32_bf16 v80, s43, v65
    v_dot2c_f32_bf16 v81, s43, v73
    v_dot2c_f32_bf16 v80, s43, v66
    v_dot2c_f32_bf16 v81, s43, v74
    v_dot2c_f32_bf16 v80, s43, v67
    v_dot2c_f32_bf16 v81, s43, v75
    v_dot2c_f32_bf16 v80, s43, v68
    v_dot2c_f32_bf16 v81, s43, v76
    v_dot2c_f32_bf16 v80, s43, v69
    v_dot2c_f32_bf16 v81, s43, v77
    v_dot2c_f32_bf16 v80, s43, v70
    v_dot2c_f32_bf16 v81, s43, v78
    v_dot2c_f32_bf16 v80, s43, v71
    v_dot2c_f32_bf16 v81, s43, v79
    s_nop 2
    v_mov_b32 v82, v80
    v_mov_b32 v83, v81
    s_nop 1
    v_permlane32_swap_b32 v80, v82
    v_permlane32_swap_b32 v81, v83
    s_nop 1
    v_add_f32 v80, v80, v82
    v_add_f32 v81, v81, v83
    s_mov_b32 exec_hi, 0
    buffer_store_dword v80, v97, s[56:59], s39 offen offset:0 sc1
    buffer_store_dword v81, v97, s[56:59], s39 offen offset:512 sc1
    s_mov_b32 exec_hi, -1
ld_nc1:
    s_lshl_b32 s52, s41, 7
    s_add_u32 s52, s52, s20
    s_add_u32 m0, s22, 0
    s_mul_i32 s53, s41, 65536
    buffer_load_dwordx4 v100, s[24:27], s52 offen offset:0 lds
    buffer_load_dwordx4 v101, s[24:27], s52 offen offset:1024 lds
    buffer_load_dwordx4 v102, s[24:27], s52 offen offset:2048 lds
    buffer_load_dwordx4 v103, s[24:27], s52 offen offset:3072 lds
    s_add_u32 s53, s53, s36
    s_add_u32 m0, s37, 0
    s_nop 0
    buffer_load_dwordx4 v104, s[28:31], s53 offen offset:0 lds
    buffer_load_dwordx4 v105, s[28:31], s53 offen offset:1024 lds
    buffer_load_dwordx4 v106, s[28:31], s53 offen offset:2048 lds
    buffer_load_dwordx4 v107, s[28:31], s53 offen offset:3072 lds
    s_add_u32 m0, s37, 4096
    s_nop 0
    buffer_load_dwordx4 v108, s[28:31], s53 offen offset:0 lds
    buffer_load_dwordx4 v109, s[28:31], s53 offen offset:1024 lds
    s_add_u32 s41, s41, 1
    s_and_b32 s41, s41, 7
    s_waitcnt vmcnt(10)
    s_barrier
    s_waitcnt vmcnt(10)
    s_mov_b32 s21, 0
ld_tp:
    v_cmp_eq_u32 vcc, 0, v89
    s_add_u32 s21, s21, 1
    s_nop 3
    s_cbranch_vccz ld_tk
    s_cmp_lt_u32 s21, 65536
    s_cbranch_scc0 ld_tk
    s_sleep 2
    buffer_load_dwordx2 v[88:89], v98, s[60:63], 0 offen sc1
    s_waitcnt vmcnt(0)
    s_branch ld_tp
ld_tk:
    s_cmp_eq_u32 s3, 4
    s_cbranch_scc0 ld_na
    s_lshl_b32 s21, s16, 4
    s_add_u32 s21, s21, s17
    s_add_u32 s23, s2, 256
    v_mov_b32 v93, s21
    v_writelane_b32 v93, s23, 1
    s_mov_b32 s21, 0x990000
    v_lshlrev_b32 v93, 7, v93
    v_mov_b32 v92, 161600
    s_mov_b64 exec, 3
    buffer_store_dwordx2 v[88:89], v93, s[56:59], s21 offen sc1
    ds_write_b64 v92, v[88:89]
    s_mov_b64 exec, -1
ld_na:
    s_lshl_b32 s52, s41, 7
    s_add_u32 s52, s52, s20
    s_add_u32 m0, s22, 16384
    s_mul_i32 s53, s41, 65536
    buffer_load_dwordx4 v100, s[24:27], s52 offen offset:0 lds
    buffer_load_dwordx4 v101, s[24:27], s52 offen offset:1024 lds
    buffer_load_dwordx4 v102, s[24:27], s52 offen offset:2048 lds
    buffer_load_dwordx4 v103, s[24:27], s52 offen offset:3072 lds
    s_add_u32 s53, s53, s36
    s_add_u32 m0, s37, 32768
    s_nop 0
    buffer_load_dwordx4 v104, s[28:31], s53 offen offset:0 lds
    buffer_load_dwordx4 v105, s[28:31], s53 offen offset:1024 lds
    buffer_load_dwordx4 v106, s[28:31], s53 offen offset:2048 lds
    buffer_load_dwordx4 v107, s[28:31], s53 offen offset:3072 lds
    s_add_u32 m0, s37, 36864
    s_nop 0
    buffer_load_dwordx4 v108, s[28:31], s53 offen offset:0 lds
    buffer_load_dwordx4 v109, s[28:31], s53 offen offset:1024 lds
    s_add_u32 s41, s41, 1
    s_and_b32 s41, s41, 7
    s_lshl2_add_u32 s21, s2, s18
    s_mul_i32 s21, s21, 1408
    v_min_u32 v254, 10, v200
    v_lshlrev_b32 v254, 7, v254
    buffer_load_dword v255, v254, s[32:35], s21 offen
    s_waitcnt vmcnt(11)
    s_barrier
    s_lshl_b32 s52, s41, 7
    s_add_u32 s52, s52, s20
    s_add_u32 m0, s22, 32768
    s_mul_i32 s53, s41, 65536
    buffer_load_dwordx4 v100, s[24:27], s52 offen offset:0 lds
    buffer_load_dwordx4 v101, s[24:27], s52 offen offset:1024 lds
    buffer_load_dwordx4 v102, s[24:27], s52 offen offset:2048 lds
    buffer_load_dwordx4 v103, s[24:27], s52 offen offset:3072 lds
    s_add_u32 s53, s53, s36
    s_add_u32 m0, s37, 65536
    s_nop 0
    buffer_load_dwordx4 v104, s[28:31], s53 offen offset:0 lds
    buffer_load_dwordx4 v105, s[28:31], s53 offen offset:1024 lds
    buffer_load_dwordx4 v106, s[28:31], s53 offen offset:2048 lds
    buffer_load_dwordx4 v107, s[28:31], s53 offen offset:3072 lds
    s_add_u32 m0, s37, 69632
    s_nop 0
    buffer_load_dwordx4 v108, s[28:31], s53 offen offset:0 lds
    buffer_load_dwordx4 v109, s[28:31], s53 offen offset:1024 lds
    s_add_u32 s41, s41, 1
    s_and_b32 s41, s41, 7
    s_waitcnt vmcnt(11)
    s_barrier
    v_and_b32 v94, 15, v200
    v_lshl_add_u32 v95, v94, 4, s17
    v_lshrrev_b32 v93, 2, v94
    v_lshlrev_b32 v93, 6, v93
    v_and_b32 v94, 3, v94
    s_lshl_b32 s21, s16, 2
    s_add_u32 s21, s21, 256
    v_add3_u32 v93, v93, v94, s21
    v_and_b32 v92, 16, v200
    v_cmp_eq_u32 vcc, 0, v92
    s_mov_b32 s55, 0x990000
    s_nop 0
    v_cndmask_b32 v95, v93, v95, vcc
    v_lshlrev_b32 v95, 7, v95
    s_lshl_b32 s21, s18, 3
    s_lshl_b64 s[50:51], 0xff, s21
    s_mov_b64 exec, s[50:51]
    buffer_load_dwordx2 v[86:87], v95, s[56:59], s55 offen sc1
    s_mov_b64 exec, -1
    s_lshl_b32 s52, s41, 7
    s_add_u32 s52, s52, s20
    s_add_u32 m0, s22, 0
    s_mul_i32 s53, s41, 65536
    buffer_load_dwordx4 v100, s[24:27], s52 offen offset:0 lds
    buffer_load_dwordx4 v101, s[24:27], s52 offen offset:1024 lds
    buffer_load_dwordx4 v102, s[24:27], s52 offen offset:2048 lds
    buffer_load_dwordx4 v103, s[24:27], s52 offen offset:3072 lds
    s_add_u32 s53, s53, s36
    s_add_u32 m0, s37, 0
    s_nop 0
    buffer_load_dwordx4 v104, s[28:31], s53 offen offset:0 lds
    buffer_load_dwordx4 v105, s[28:31], s53 offen offset:1024 lds
    buffer_load_dwordx4 v106, s[28:31], s53 offen offset:2048 lds
    buffer_load_dwordx4 v107, s[28:31], s53 offen offset:3072 lds
    s_add_u32 m0, s37, 4096
    s_nop 0
    buffer_load_dwordx4 v108, s[28:31], s53 offen offset:0 lds
    buffer_load_dwordx4 v109, s[28:31], s53 offen offset:1024 lds
    s_add_u32 s41, s41, 1
    s_and_b32 s41, s41, 7
    s_lshl_b32 s21, s17, 14
    s_lshl_b32 s23, s18, 8
    s_add_u32 s21, s21, s23
    s_add_u32 s100, s21, 0x910000
    v_and_b32 v92, 15, v200
    v_lshrrev_b32 v93, 4, v200
    v_lshlrev_b32 v92, 4, v92
    v_lshl_add_u32 v84, v93, 10, v92
    s_and_b32 s23, s18, 1
    s_lshl_b32 s21, s16, 10
    s_lshl_b32 s23, s23, 9
    v_lshlrev_b32 v94, 3, v200
    s_add_u32 s21, s21, s23
    s_add_u32 s101, s21, 0x900000
    v_mov_b32 v83, 161616
    v_mov_b32 v82, 1
    v_mov_b32 v226, v88
    v_mov_b32 v227, v89
    s_waitcnt vmcnt(11)
    s_barrier
    s_waitcnt vmcnt(10)
    s_mov_b32 s21, 0
    s_mov_b64 exec, s[50:51]
ld_sp:
    v_cmp_ne_u64 vcc, v[88:89], v[86:87]
    s_add_u32 s21, s21, 1
    s_nop 3
    s_cbranch_vccz ld_ok
    s_cmp_lt_u32 s21, 65536
    s_cbranch_scc0 ld_ok
    s_sleep 2
    buffer_load_dwordx2 v[86:87], v95, s[56:59], s55 offen sc1
    s_waitcnt vmcnt(0)
    s_branch ld_sp
ld_ok:
    s_mov_b64 exec, 1
    ds_add_u32 v83, v82
    s_mov_b32 s21, 0
ld_lw:
    ds_read_b32 v82, v83
    s_add_u32 s21, s21, 1
    s_waitcnt lgkmcnt(0)
    v_cmp_ne_u32 vcc, 4, v82
    s_cmp_lt_u32 s21, 1048576
    s_nop 2
    s_cbranch_vccz ld_lx
    s_cbranch_scc1 ld_lw
ld_lx:
    s_mov_b64 exec, -1
    buffer_load_dwordx4 v[64:67], v84, s[56:59], s100 offen sc1
    s_add_u32 s100, s100, 4096
    buffer_load_dwordx4 v[68:71], v84, s[56:59], s100 offen sc1
    s_add_u32 s100, s100, 4096
    buffer_load_dwordx4 v[72:75], v84, s[56:59], s100 offen sc1
    s_add_u32 s100, s100, 4096
    buffer_load_dwordx4 v[76:79], v84, s[56:59], s100 offen sc1
    buffer_load_dwordx2 v[80:81], v94, s[56:59], s101 offen sc1
    s_lshl_b32 s52, s41, 7
    s_add_u32 s52, s52, s20
    s_add_u32 m0, s22, 16384
    s_mul_i32 s53, s41, 65536
    buffer_load_dwordx4 v100, s[24:27], s52 offen offset:0 lds
    buffer_load_dwordx4 v101, s[24:27], s52 offen offset:1024 lds
    buffer_load_dwordx4 v102, s[24:27], s52 offen offset:2048 lds
    buffer_load_dwordx4 v103, s[24:27], s52 offen offset:3072 lds
    s_add_u32 s53, s53, s36
    s_add_u32 m0, s37, 32768
    s_nop 0
    buffer_load_dwordx4 v104, s[28:31], s53 offen offset:0 lds
    buffer_load_dwordx4 v105, s[28:31], s53 offen offset:1024 lds
    buffer_load_dwordx4 v106, s[28:31], s53 offen offset:2048 lds
    buffer_load_dwordx4 v107, s[28:31], s53 offen offset:3072 lds
    s_add_u32 m0, s37, 36864
    s_nop 0
    buffer_load_dwordx4 v108, s[28:31], s53 offen offset:0 lds
    buffer_load_dwordx4 v109, s[28:31], s53 offen offset:1024 lds
    s_add_u32 s41, s41, 1
    s_and_b32 s41, s41, 7
    s_waitcnt vmcnt(15)
    s_barrier
    s_lshl_b32 s75, s18, 14
    s_lshl_b32 s21, s71, 7
    s_add_u32 s75, s75, s21
    s_lshl_b32 s22, s18, 11
    s_waitcnt vmcnt(10)
    v_pk_add_f32 v[64:65], v[64:65], v[72:73]
    v_pk_add_f32 v[66:67], v[66:67], v[74:75]
    v_pk_add_f32 v[68:69], v[68:69], v[76:77]
    v_pk_add_f32 v[70:71], v[70:71], v[78:79]
    v_pk_add_f32 v[64:65], v[64:65], v[68:69]
    v_pk_add_f32 v[66:67], v[66:67], v[70:71]
    v_mov_b32 v68, v64
    v_mov_b32 v69, v65
    v_mov_b32 v70, v66
    v_mov_b32 v71, v67
    s_nop 1
    v_permlane16_swap_b32 v64, v68
    v_permlane16_swap_b32 v65, v69
    v_permlane16_swap_b32 v66, v70
    v_permlane16_swap_b32 v67, v71
    s_nop 1
    v_pk_add_f32 v[64:65], v[64:65], v[68:69]
    v_pk_add_f32 v[66:67], v[66:67], v[70:71]
    v_mov_b32 v68, v64
    v_mov_b32 v69, v65
    v_mov_b32 v70, v66
    v_mov_b32 v71, v67
    s_nop 1
    v_permlane32_swap_b32 v64, v68
    v_permlane32_swap_b32 v65, v69
    v_permlane32_swap_b32 v66, v70
    v_permlane32_swap_b32 v67, v71
    s_nop 1
    v_pk_add_f32 v[64:65], v[64:65], v[68:69]
    v_pk_add_f32 v[66:67], v[66:67], v[70:71]
    v_rsq_f32 v81, v81
    s_lshl_b32 s21, s18, 8
    s_add_u32 s21, s21, 162816
    v_add_u32 v94, s21, v92
    ds_write_b128 v94, v[64:67]
    s_and_b32 s21, s18, 1
    s_lshl_b32 s21, s21, 8
    s_add_u32 s21, s21, 161792
    v_add_u32 v94, s21, v97
    ds_write_b32 v94, v80
    ds_write_b32 v94, v81 offset:512
    s_waitcnt lgkmcnt(0)
    s_waitcnt vmcnt(0)
    s_barrier
    s_lshl_b32 s53, s74, 16
    s_add_u32 s53, s53, s75
    s_add_u32 m0, s22, 32768
    s_add_u32 s74, s74, 1
    s_cmp_eq_u32 s74, 22
    s_cselect_b32 s74, 0, s74
    buffer_load_dwordx4 v220, s[32:35], s53 offen offset:0 lds
    buffer_load_dwordx4 v221, s[32:35], s53 offen offset:1024 lds
    s_waitcnt vmcnt(6)
    s_lshl_b32 s53, s74, 16
    s_add_u32 s53, s53, s75
    s_add_u32 m0, s22, 40960
    s_add_u32 s74, s74, 1
    s_cmp_eq_u32 s74, 22
    s_cselect_b32 s74, 0, s74
    buffer_load_dwordx4 v220, s[32:35], s53 offen offset:0 lds
    buffer_load_dwordx4 v221, s[32:35], s53 offen offset:1024 lds
    s_waitcnt vmcnt(6)
    s_lshl_b32 s53, s74, 16
    s_add_u32 s53, s53, s75
    s_add_u32 m0, s22, 114688
    s_add_u32 s74, s74, 1
    s_cmp_eq_u32 s74, 22
    s_cselect_b32 s74, 0, s74
    buffer_load_dwordx4 v220, s[32:35], s53 offen offset:0 lds
    buffer_load_dwordx4 v221, s[32:35], s53 offen offset:1024 lds
    s_waitcnt vmcnt(6)
    s_barrier
    s_lshl_b32 s53, s74, 16
    s_add_u32 s53, s53, s75
    s_add_u32 m0, s22, 122880
    s_add_u32 s74, s74, 1
    s_cmp_eq_u32 s74, 22
    s_cselect_b32 s74, 0, s74
    buffer_load_dwordx4 v220, s[32:35], s53 offen offset:0 lds
    buffer_load_dwordx4 v221, s[32:35], s53 offen offset:1024 lds
    s_lshl_b32 s53, s74, 16
    s_add_u32 s53, s53, s75
    s_add_u32 m0, s22, 131072
    s_add_u32 s74, s74, 1
    s_cmp_eq_u32 s74, 22
    s_cselect_b32 s74, 0, s74
    buffer_load_dwordx4 v220, s[32:35], s53 offen offset:0 lds
    buffer_load_dwordx4 v221, s[32:35], s53 offen offset:1024 lds
    s_lshl_b32 s53, s74, 16
    s_add_u32 s53, s53, s75
    s_add_u32 m0, s22, 139264
    s_add_u32 s74, s74, 1
    s_cmp_eq_u32 s74, 22
    s_cselect_b32 s74, 0, s74
    buffer_load_dwordx4 v220, s[32:35], s53 offen offset:0 lds
    buffer_load_dwordx4 v221, s[32:35], s53 offen offset:1024 lds
    s_lshl_b32 s53, s74, 16
    s_add_u32 s53, s53, s75
    s_add_u32 m0, s22, 147456
    s_add_u32 s74, s74, 1
    s_cmp_eq_u32 s74, 22
    s_cselect_b32 s74, 0, s74
    buffer_load_dwordx4 v220, s[32:35], s53 offen offset:0 lds
    buffer_load_dwordx4 v221, s[32:35], s53 offen offset:1024 lds
    s_lshl_b32 s53, s74, 16
    s_add_u32 s53, s53, s75
    s_add_u32 m0, s22, 0
    s_add_u32 s74, s74, 1
    s_cmp_eq_u32 s74, 22
    s_cselect_b32 s74, 0, s74
    buffer_load_dwordx4 v220, s[32:35], s53 offen offset:0 lds
    buffer_load_dwordx4 v221, s[32:35], s53 offen offset:1024 lds
    s_lshl_b32 s53, s74, 16
    s_add_u32 s53, s53, s75
    s_add_u32 m0, s22, 8192
    s_add_u32 s74, s74, 1
    s_cmp_eq_u32 s74, 22
    s_cselect_b32 s74, 0, s74
    buffer_load_dwordx4 v220, s[32:35], s53 offen offset:0 lds
    buffer_load_dwordx4 v221, s[32:35], s53 offen offset:1024 lds
    s_lshl_b32 s53, s74, 16
    s_add_u32 s53, s53, s75
    s_add_u32 m0, s22, 49152
    s_add_u32 s74, s74, 1
    s_cmp_eq_u32 s74, 22
    s_cselect_b32 s74, 0, s74
    buffer_load_dwordx4 v220, s[32:35], s53 offen offset:0 lds
    buffer_load_dwordx4 v221, s[32:35], s53 offen offset:1024 lds
    v_and_b32 v216, 31, v200
    v_lshrrev_b32 v217, 5, v200
    v_mul_u32_u24 v217, 73728, v217
    v_lshl_add_u32 v217, v216, 4, v217
    s_mul_i32 s52, s16, 4608
    s_lshl_b32 s53, s19, 4
    s_add_u32 s52, s52, s53
    s_mul_i32 s53, s3, 294912
    s_add_u32 s52, s52, s53
    s_add_u32 s52, s52, 0x600000
    s_add_u32 s53, s52, 147456
    s_lshl_b32 s21, s3, 9
    s_add_u32 s21, s21, 16384
    v_lshl_add_u32 v216, v200, 2, s21
    v_add_u32 v218, 65536, v216
    s_cmp_eq_u32 s17, 15
    s_cselect_b32 s54, 1, -1
    s_barrier
    ds_read2st64_b32 v[0:1], v216 offset0:0 offset1:16
    ds_read2st64_b32 v[2:3], v216 offset0:32 offset1:48
    ds_read2st64_b32 v[4:5], v216 offset0:1 offset1:17
    ds_read2st64_b32 v[6:7], v216 offset0:33 offset1:49
    ds_read2st64_b32 v[8:9], v218 offset0:0 offset1:16
    ds_read2st64_b32 v[10:11], v218 offset0:32 offset1:48
    ds_read2st64_b32 v[12:13], v218 offset0:1 offset1:17
    ds_read2st64_b32 v[14:15], v218 offset0:33 offset1:49
    ds_read2st64_b32 v[16:17], v218 offset0:64 offset1:80
    ds_read2st64_b32 v[18:19], v218 offset0:96 offset1:112
    ds_read2st64_b32 v[20:21], v218 offset0:65 offset1:81
    ds_read2st64_b32 v[22:23], v218 offset0:97 offset1:113
    s_waitcnt lgkmcnt(10)
    buffer_store_dwordx4 v[0:3], v217, s[56:59], s52 offen offset:0 sc1
    s_waitcnt lgkmcnt(8)
    buffer_store_dwordx4 v[4:7], v217, s[56:59], s53 offen offset:0 sc1
    s_waitcnt lgkmcnt(6)
    buffer_store_dwordx4 v[8:11], v217, s[56:59], s52 offen offset:512 sc1
    s_waitcnt lgkmcnt(4)
    buffer_store_dwordx4 v[12:15], v217, s[56:59], s53 offen offset:512 sc1
    s_waitcnt lgkmcnt(2)
    s_mov_b32 exec_lo, s54
    s_mov_b32 exec_hi, s54
    buffer_store_dwordx4 v[16:19], v217, s[56:59], s52 offen offset:1024 sc1
    s_waitcnt lgkmcnt(0)
    buffer_store_dwordx4 v[20:23], v217, s[56:59], s53 offen offset:1024 sc1
    s_mov_b64 exec, -1
    s_lshl_b32 s53, s74, 16
    s_add_u32 s53, s53, s75
    s_add_u32 m0, s22, 57344
    s_add_u32 s74, s74, 1
    s_cmp_eq_u32 s74, 22
    s_cselect_b32 s74, 0, s74
    buffer_load_dwordx4 v220, s[32:35], s53 offen offset:0 lds
    buffer_load_dwordx4 v221, s[32:35], s53 offen offset:1024 lds
    s_lshl_b32 s53, s74, 16
    s_add_u32 s53, s53, s75
    s_add_u32 m0, s22, 65536
    s_add_u32 s74, s74, 1
    s_cmp_eq_u32 s74, 22
    s_cselect_b32 s74, 0, s74
    buffer_load_dwordx4 v220, s[32:35], s53 offen offset:0 lds
    buffer_load_dwordx4 v221, s[32:35], s53 offen offset:1024 lds
    s_lshl_b32 s53, s74, 16
    s_add_u32 s53, s53, s75
    s_add_u32 m0, s22, 73728
    s_add_u32 s74, s74, 1
    s_cmp_eq_u32 s74, 22
    s_cselect_b32 s74, 0, s74
    buffer_load_dwordx4 v220, s[32:35], s53 offen offset:0 lds
    buffer_load_dwordx4 v221, s[32:35], s53 offen offset:1024 lds
    s_waitcnt vmcnt(6)
    s_barrier
    s_branch p2_b
cd:
    v_lshlrev_b32 v204, 4, v200
    s_lshr_b32 s20, s2, 6
    s_lshl_b32 s20, s20, 2
    s_add_u32 s20, s20, s18
    s_lshl_b32 s20, s20, 17
    s_and_b32 s21, s2, 63
    s_lshl_b32 s21, s21, 10
    s_add_u32 s21, s21, s20
    s_add_u32 s22, s21, 65536
    s_mov_b32 s24, s4
    s_and_b32 s25, s5, 0xffff
    s_mov_b32 s26, 0x200000
    s_mov_b32 s27, 0x00020000
    buffer_load_dwordx4 v[112:115], v204, s[24:27], s21 offen
    buffer_load_dwordx4 v[116:119], v204, s[24:27], s22 offen
    s_mov_b32 s56, s6
    s_and_b32 s57, s7, 0xffff
    s_mov_b32 s58, 0x10000000
    s_mov_b32 s59, 0x00020000
    v_and_b32 v204, 31, v200
    v_lshrrev_b32 v205, 5, v200
    v_bfe_u32 v206, v200, 1, 3
    v_xor_b32 v206, v206, v205
    s_lshl_b32 s21, s18, 12
    v_lshl_add_u32 v207, v204, 7, s21
    v_xor_b32 v208, 0, v206
    v_lshl_add_u32 v176, v208, 4, v207
    v_xor_b32 v208, 2, v206
    v_lshl_add_u32 v177, v208, 4, v207
    v_xor_b32 v208, 4, v206
    v_lshl_add_u32 v178, v208, 4, v207
    v_xor_b32 v208, 6, v206
    v_lshl_add_u32 v179, v208, 4, v207
    s_mov_b32 s23, 49152
    v_lshrrev_b32 v205, 5, v200
    v_bfe_u32 v206, v200, 2, 2
    v_lshl_add_u32 v206, v205, 3, v206
    v_mul_u32_u24 v206, 192, v206
    v_and_b32 v207, 3, v200
    v_lshl_add_u32 v206, v207, 3, v206
    v_bfe_u32 v207, v200, 4, 1
    v_mul_u32_u24 v207, 32, v207
    v_add3_u32 v180, v206, v207, s23
    v_mov_b32 v0, 0
    v_mov_b32 v1, 0
    v_mov_b32 v2, 0
    v_mov_b32 v3, 0
    v_mov_b32 v4, 0
    v_mov_b32 v5, 0
    v_mov_b32 v6, 0
    v_mov_b32 v7, 0
    v_mov_b32 v8, 0
    v_mov_b32 v9, 0
    v_mov_b32 v10, 0
    v_mov_b32 v11, 0
    v_mov_b32 v12, 0
    v_mov_b32 v13, 0
    v_mov_b32 v14, 0
    v_mov_b32 v15, 0
    v_mov_b32 v16, 0
    v_mov_b32 v17, 0
    v_mov_b32 v18, 0
    v_mov_b32 v19, 0
    v_mov_b32 v20, 0
    v_mov_b32 v21, 0
    v_mov_b32 v22, 0
    v_mov_b32 v23, 0
    v_mov_b32 v24, 0
    v_mov_b32 v25, 0
    v_mov_b32 v26, 0
    v_mov_b32 v27, 0
    v_mov_b32 v28, 0
    v_mov_b32 v29, 0
    v_mov_b32 v30, 0
    v_mov_b32 v31, 0
    v_mov_b32 v32, 0
    v_mov_b32 v33, 0
    v_mov_b32 v34, 0
    v_mov_b32 v35, 0
    v_mov_b32 v36, 0
    v_mov_b32 v37, 0
    v_mov_b32 v38, 0
    v_mov_b32 v39, 0
    v_mov_b32 v40, 0
    v_mov_b32 v41, 0
    v_mov_b32 v42, 0
    v_mov_b32 v43, 0
    v_mov_b32 v44, 0
    v_mov_b32 v45, 0
    v_mov_b32 v46, 0
    v_mov_b32 v47, 0
    v_mov_b32 v48, 0
    v_mov_b32 v49, 0
    v_mov_b32 v50, 0
    v_mov_b32 v51, 0
    v_mov_b32 v52, 0
    v_mov_b32 v53, 0
    v_mov_b32 v54, 0
    v_mov_b32 v55, 0
    v_mov_b32 v56, 0
    v_mov_b32 v57, 0
    v_mov_b32 v58, 0
    v_mov_b32 v59, 0
    v_mov_b32 v60, 0
    v_mov_b32 v61, 0
    v_mov_b32 v62, 0
    v_mov_b32 v63, 0
    v_mov_b32 v64, 0
    v_mov_b32 v65, 0
    v_mov_b32 v66, 0
    v_mov_b32 v67, 0
    v_mov_b32 v68, 0
    v_mov_b32 v69, 0
    v_mov_b32 v70, 0
    v_mov_b32 v71, 0
    v_mov_b32 v72, 0
    v_mov_b32 v73, 0
    v_mov_b32 v74, 0
    v_mov_b32 v75, 0
    v_mov_b32 v76, 0
    v_mov_b32 v77, 0
    v_mov_b32 v78, 0
    v_mov_b32 v79, 0
    v_mov_b32 v80, 0
    v_mov_b32 v81, 0
    v_mov_b32 v82, 0
    v_mov_b32 v83, 0
    v_mov_b32 v84, 0
    v_mov_b32 v85, 0
    v_mov_b32 v86, 0
    v_mov_b32 v87, 0
    v_mov_b32 v88, 0
    v_mov_b32 v89, 0
    v_mov_b32 v90, 0
    v_mov_b32 v91, 0
    v_mov_b32 v92, 0
    v_mov_b32 v93, 0
    v_mov_b32 v94, 0
    v_mov_b32 v95, 0
    v_mov_b32 v144, 0
    v_mov_b32 v145, 0
    v_mov_b32 v146, 0
    v_mov_b32 v147, 0
    v_mov_b32 v148, 0
    v_mov_b32 v149, 0
    v_mov_b32 v150, 0
    v_mov_b32 v151, 0
    v_mov_b32 v152, 0
    v_mov_b32 v153, 0
    v_mov_b32 v154, 0
    v_mov_b32 v155, 0
    v_mov_b32 v156, 0
    v_mov_b32 v157, 0
    v_mov_b32 v158, 0
    v_mov_b32 v159, 0
    v_mov_b32 v160, 0
    v_mov_b32 v161, 0
    v_mov_b32 v162, 0
    v_mov_b32 v163, 0
    v_mov_b32 v164, 0
    v_mov_b32 v165, 0
    v_mov_b32 v166, 0
    v_mov_b32 v167, 0
    v_mov_b32 v168, 0
    v_mov_b32 v169, 0
    v_mov_b32 v170, 0
    v_mov_b32 v171, 0
    s_mov_b32 s21, 0x3d000000
    v_lshl_add_u32 v208, v205, 2, 0
    v_lshl_add_u32 v209, v205, 2, 1
    v_lshl_add_u32 v210, v205, 2, 2
    v_lshl_add_u32 v211, v205, 2, 3
    v_mul_u32_u24 v208, v208, v204
    v_mul_u32_u24 v209, v209, v204
    v_mul_u32_u24 v210, v210, v204
    v_mul_u32_u24 v211, v211, v204
    v_and_b32 v208, 31, v208
    v_and_b32 v209, 31, v209
    v_and_b32 v210, 31, v210
    v_and_b32 v211, 31, v211
    v_cvt_f32_u32 v208, v208
    v_cvt_f32_u32 v209, v209
    v_cvt_f32_u32 v210, v210
    v_cvt_f32_u32 v211, v211
    v_mul_f32 v208, s21, v208
    v_mul_f32 v209, s21, v209
    v_mul_f32 v210, s21, v210
    v_mul_f32 v211, s21, v211
    v_cos_f32 v212, v208
    v_cos_f32 v213, v209
    v_cos_f32 v214, v210
    v_cos_f32 v215, v211
    v_sin_f32 v208, v208
    v_sin_f32 v209, v209
    v_sin_f32 v210, v210
    v_sin_f32 v211, v211
    v_cvt_pk_bf16_f32 v224, v212, v213
    v_cvt_pk_bf16_f32 v232, v208, v209
    v_xor_b32 v240, 0x80008000, v232
    v_cvt_pk_bf16_f32 v225, v214, v215
    v_cvt_pk_bf16_f32 v233, v210, v211
    v_xor_b32 v241, 0x80008000, v233
    v_lshl_add_u32 v208, v205, 2, 8
    v_lshl_add_u32 v209, v205, 2, 9
    v_lshl_add_u32 v210, v205, 2, 10
    v_lshl_add_u32 v211, v205, 2, 11
    v_mul_u32_u24 v208, v208, v204
    v_mul_u32_u24 v209, v209, v204
    v_mul_u32_u24 v210, v210, v204
    v_mul_u32_u24 v211, v211, v204
    v_and_b32 v208, 31, v208
    v_and_b32 v209, 31, v209
    v_and_b32 v210, 31, v210
    v_and_b32 v211, 31, v211
    v_cvt_f32_u32 v208, v208
    v_cvt_f32_u32 v209, v209
    v_cvt_f32_u32 v210, v210
    v_cvt_f32_u32 v211, v211
    v_mul_f32 v208, s21, v208
    v_mul_f32 v209, s21, v209
    v_mul_f32 v210, s21, v210
    v_mul_f32 v211, s21, v211
    v_cos_f32 v212, v208
    v_cos_f32 v213, v209
    v_cos_f32 v214, v210
    v_cos_f32 v215, v211
    v_sin_f32 v208, v208
    v_sin_f32 v209, v209
    v_sin_f32 v210, v210
    v_sin_f32 v211, v211
    v_cvt_pk_bf16_f32 v226, v212, v213
    v_cvt_pk_bf16_f32 v234, v208, v209
    v_xor_b32 v242, 0x80008000, v234
    v_cvt_pk_bf16_f32 v227, v214, v215
    v_cvt_pk_bf16_f32 v235, v210, v211
    v_xor_b32 v243, 0x80008000, v235
    v_lshl_add_u32 v208, v205, 2, 16
    v_lshl_add_u32 v209, v205, 2, 17
    v_lshl_add_u32 v210, v205, 2, 18
    v_lshl_add_u32 v211, v205, 2, 19
    v_mul_u32_u24 v208, v208, v204
    v_mul_u32_u24 v209, v209, v204
    v_mul_u32_u24 v210, v210, v204
    v_mul_u32_u24 v211, v211, v204
    v_and_b32 v208, 31, v208
    v_and_b32 v209, 31, v209
    v_and_b32 v210, 31, v210
    v_and_b32 v211, 31, v211
    v_cvt_f32_u32 v208, v208
    v_cvt_f32_u32 v209, v209
    v_cvt_f32_u32 v210, v210
    v_cvt_f32_u32 v211, v211
    v_mul_f32 v208, s21, v208
    v_mul_f32 v209, s21, v209
    v_mul_f32 v210, s21, v210
    v_mul_f32 v211, s21, v211
    v_cos_f32 v212, v208
    v_cos_f32 v213, v209
    v_cos_f32 v214, v210
    v_cos_f32 v215, v211
    v_sin_f32 v208, v208
    v_sin_f32 v209, v209
    v_sin_f32 v210, v210
    v_sin_f32 v211, v211
    v_cvt_pk_bf16_f32 v228, v212, v213
    v_cvt_pk_bf16_f32 v236, v208, v209
    v_xor_b32 v244, 0x80008000, v236
    v_cvt_pk_bf16_f32 v229, v214, v215
    v_cvt_pk_bf16_f32 v237, v210, v211
    v_xor_b32 v245, 0x80008000, v237
    v_lshl_add_u32 v208, v205, 2, 24
    v_lshl_add_u32 v209, v205, 2, 25
    v_lshl_add_u32 v210, v205, 2, 26
    v_lshl_add_u32 v211, v205, 2, 27
    v_mul_u32_u24 v208, v208, v204
    v_mul_u32_u24 v209, v209, v204
    v_mul_u32_u24 v210, v210, v204
    v_mul_u32_u24 v211, v211, v204
    v_and_b32 v208, 31, v208
    v_and_b32 v209, 31, v209
    v_and_b32 v210, 31, v210
    v_and_b32 v211, 31, v211
    v_cvt_f32_u32 v208, v208
    v_cvt_f32_u32 v209, v209
    v_cvt_f32_u32 v210, v210
    v_cvt_f32_u32 v211, v211
    v_mul_f32 v208, s21, v208
    v_mul_f32 v209, s21, v209
    v_mul_f32 v210, s21, v210
    v_mul_f32 v211, s21, v211
    v_cos_f32 v212, v208
    v_cos_f32 v213, v209
    v_cos_f32 v214, v210
    v_cos_f32 v215, v211
    v_sin_f32 v208, v208
    v_sin_f32 v209, v209
    v_sin_f32 v210, v210
    v_sin_f32 v211, v211
    v_cvt_pk_bf16_f32 v230, v212, v213
    v_cvt_pk_bf16_f32 v238, v208, v209
    v_xor_b32 v246, 0x80008000, v238
    v_cvt_pk_bf16_f32 v231, v214, v215
    v_cvt_pk_bf16_f32 v239, v210, v211
    v_xor_b32 v247, 0x80008000, v239
    v_mov_b32 v120, 0
    v_mov_b32 v121, 0
    v_mov_b32 v122, 0
    v_mov_b32 v123, 0
    s_mov_b32 s31, 0x3f803f80
    s_waitcnt vmcnt(0)
    v_dot2c_f32_bf16 v120, v112, v112
    v_dot2c_f32_bf16 v121, s31, v112
    v_dot2c_f32_bf16 v122, v116, v116
    v_dot2c_f32_bf16 v123, s31, v116
    v_dot2c_f32_bf16 v120, v113, v113
    v_dot2c_f32_bf16 v121, s31, v113
    v_dot2c_f32_bf16 v122, v117, v117
    v_dot2c_f32_bf16 v123, s31, v117
    v_dot2c_f32_bf16 v120, v114, v114
    v_dot2c_f32_bf16 v121, s31, v114
    v_dot2c_f32_bf16 v122, v118, v118
    v_dot2c_f32_bf16 v123, s31, v118
    v_dot2c_f32_bf16 v120, v115, v115
    v_dot2c_f32_bf16 v121, s31, v115
    v_dot2c_f32_bf16 v122, v119, v119
    v_dot2c_f32_bf16 v123, s31, v119
    s_nop 2
    v_add_f32_dpp v120, v120, v120 row_shr:1 bound_ctrl:0
    v_add_f32_dpp v121, v121, v121 row_shr:1 bound_ctrl:0
    v_add_f32_dpp v122, v122, v122 row_shr:1 bound_ctrl:0
    v_add_f32_dpp v123, v123, v123 row_shr:1 bound_ctrl:0
    v_add_f32_dpp v120, v120, v120 row_shr:2 bound_ctrl:0
    v_add_f32_dpp v121, v121, v121 row_shr:2 bound_ctrl:0
    v_add_f32_dpp v122, v122, v122 row_shr:2 bound_ctrl:0
    v_add_f32_dpp v123, v123, v123 row_shr:2 bound_ctrl:0
    v_add_f32_dpp v120, v120, v120 row_shr:4 bound_ctrl:0
    v_add_f32_dpp v121, v121, v121 row_shr:4 bound_ctrl:0
    v_add_f32_dpp v122, v122, v122 row_shr:4 bound_ctrl:0
    v_add_f32_dpp v123, v123, v123 row_shr:4 bound_ctrl:0
    v_add_f32_dpp v120, v120, v120 row_shr:8 bound_ctrl:0
    v_add_f32_dpp v121, v121, v121 row_shr:8 bound_ctrl:0
    v_add_f32_dpp v122, v122, v122 row_shr:8 bound_ctrl:0
    v_add_f32_dpp v123, v123, v123 row_shr:8 bound_ctrl:0
    v_add_f32_dpp v120, v120, v120 row_bcast:15 row_mask:0xa
    v_add_f32_dpp v121, v121, v121 row_bcast:15 row_mask:0xa
    v_add_f32_dpp v122, v122, v122 row_bcast:15 row_mask:0xa
    v_add_f32_dpp v123, v123, v123 row_bcast:15 row_mask:0xa
    v_add_f32_dpp v120, v120, v120 row_bcast:31 row_mask:0xc
    v_add_f32_dpp v121, v121, v121 row_bcast:31 row_mask:0xc
    v_add_f32_dpp v122, v122, v122 row_bcast:31 row_mask:0xc
    v_add_f32_dpp v123, v123, v123 row_bcast:31 row_mask:0xc
    v_mov_b32 v128, 0x3b000000
    v_mul_f32 v124, v128, v121
    v_mul_f32 v129, v124, v124
    v_fma_f32 v125, v120, v128, -v129
    v_max_f32 v125, 0, v125
    v_add_f32 v125, 0x3727c5ac, v125
    v_mul_f32 v126, v128, v123
    v_mul_f32 v129, v126, v126
    v_fma_f32 v127, v122, v128, -v129
    v_max_f32 v127, 0, v127
    v_add_f32 v127, 0x3727c5ac, v127
    s_lshl_b32 s21, s18, 4
    s_add_u32 s21, s21, 161536
    v_mov_b32 v129, s21
    s_lshl_b64 exec, 1, 63
    ds_write_b128 v129, v[124:127]
    s_mov_b64 exec, -1
    s_mov_b32 s42, 0
    s_mov_b32 s43, 0
    s_mov_b32 s47, 16384
    v_and_b32 v216, 31, v200
    v_lshrrev_b32 v217, 5, v200
    v_mul_u32_u24 v217, 73728, v217
    v_lshl_add_u32 v217, v216, 4, v217
    s_mul_i32 s52, s16, 4608
    s_lshl_b32 s53, s19, 4
    s_add_u32 s52, s52, s53
    s_mul_i32 s53, s3, 294912
    s_add_u32 s52, s52, s53
    s_add_u32 s52, s52, 0x600000
    s_add_u32 s53, s52, 147456
    s_lshl_b32 s21, s3, 9
    s_add_u32 s21, s21, 16384
    v_lshl_add_u32 v216, v200, 2, s21
    v_add_u32 v218, 65536, v216
    s_cmp_eq_u32 s17, 15
    s_cselect_b32 s54, 1, -1
    s_lshl_b32 s55, s16, 4
    s_add_u32 s55, s55, s17
    s_lshl_b32 s55, s55, 7
    s_add_u32 s55, s55, 0x980000
    s_setprio 1
cd_loop:
    s_waitcnt lgkmcnt(0)
    s_barrier
    v_mfma_f32_32x32x16_bf16 v[0:15], v[144:147], v[148:151], v[0:15]
    ds_read_b128 v[112:115], v176
    ds_read_b64_tr_b16 v[116:117], v180 offset:0
    ds_read_b64_tr_b16 v[118:119], v180 offset:768
    v_mfma_f32_32x32x16_bf16 v[16:31], v[144:147], v[152:155], v[16:31]
    ds_read_b64_tr_b16 v[120:121], v180 offset:14464
    ds_read_b64_tr_b16 v[122:123], v180 offset:15232
    ds_read_b64_tr_b16 v[124:125], v180 offset:64
    v_mfma_f32_32x32x16_bf16 v[32:47], v[144:147], v[156:159], v[32:47]
    ds_read_b64_tr_b16 v[126:127], v180 offset:832
    ds_read_b64_tr_b16 v[128:129], v180 offset:14528
    v_mfma_f32_32x32x16_bf16 v[48:63], v[144:147], v[160:163], v[48:63]
    ds_read_b64_tr_b16 v[130:131], v180 offset:15296
    ds_read_b64_tr_b16 v[132:133], v180 offset:128
    ds_read_b64_tr_b16 v[134:135], v180 offset:896
    v_mfma_f32_32x32x16_bf16 v[64:79], v[144:147], v[164:167], v[64:79]
    ds_read_b64_tr_b16 v[136:137], v180 offset:14592
    ds_read_b64_tr_b16 v[138:139], v180 offset:15360
    v_mfma_f32_32x32x16_bf16 v[80:95], v[144:147], v[168:171], v[80:95]
    s_waitcnt lgkmcnt(0)
    v_mfma_f32_32x32x16_bf16 v[0:15], v[112:115], v[116:119], v[0:15]
    ds_read_b128 v[144:147], v177
    ds_read_b64_tr_b16 v[148:149], v180 offset:3072
    ds_read_b64_tr_b16 v[150:151], v180 offset:3840
    v_mfma_f32_32x32x16_bf16 v[16:31], v[112:115], v[120:123], v[16:31]
    ds_read_b64_tr_b16 v[152:153], v180 offset:17536
    ds_read_b64_tr_b16 v[154:155], v180 offset:18304
    ds_read_b64_tr_b16 v[156:157], v180 offset:3136
    v_mfma_f32_32x32x16_bf16 v[32:47], v[112:115], v[124:127], v[32:47]
    ds_read_b64_tr_b16 v[158:159], v180 offset:3904
    ds_read_b64_tr_b16 v[160:161], v180 offset:17600
    v_mfma_f32_32x32x16_bf16 v[48:63], v[112:115], v[128:131], v[48:63]
    ds_read_b64_tr_b16 v[162:163], v180 offset:18368
    ds_read_b64_tr_b16 v[164:165], v180 offset:3200
    ds_read_b64_tr_b16 v[166:167], v180 offset:3968
    v_mfma_f32_32x32x16_bf16 v[64:79], v[112:115], v[132:135], v[64:79]
    ds_read_b64_tr_b16 v[168:169], v180 offset:17664
    ds_read_b64_tr_b16 v[170:171], v180 offset:18432
    v_mfma_f32_32x32x16_bf16 v[80:95], v[112:115], v[136:139], v[80:95]
    s_waitcnt lgkmcnt(0)
    v_mfma_f32_32x32x16_bf16 v[0:15], v[144:147], v[148:151], v[0:15]
    ds_read_b128 v[112:115], v178
    ds_read_b64_tr_b16 v[116:117], v180 offset:6144
    ds_read_b64_tr_b16 v[118:119], v180 offset:6912
    v_mfma_f32_32x32x16_bf16 v[16:31], v[144:147], v[152:155], v[16:31]
    ds_read_b64_tr_b16 v[120:121], v180 offset:20608
    ds_read_b64_tr_b16 v[122:123], v180 offset:21376
    ds_read_b64_tr_b16 v[124:125], v180 offset:6208
    v_mfma_f32_32x32x16_bf16 v[32:47], v[144:147], v[156:159], v[32:47]
    ds_read_b64_tr_b16 v[126:127], v180 offset:6976
    ds_read_b64_tr_b16 v[128:129], v180 offset:20672
    v_mfma_f32_32x32x16_bf16 v[48:63], v[144:147], v[160:163], v[48:63]
    ds_read_b64_tr_b16 v[130:131], v180 offset:21440
    ds_read_b64_tr_b16 v[132:133], v180 offset:6272
    ds_read_b64_tr_b16 v[134:135], v180 offset:7040
    v_mfma_f32_32x32x16_bf16 v[64:79], v[144:147], v[164:167], v[64:79]
    ds_read_b64_tr_b16 v[136:137], v180 offset:20736
    ds_read_b64_tr_b16 v[138:139], v180 offset:21504
    v_mfma_f32_32x32x16_bf16 v[80:95], v[144:147], v[168:171], v[80:95]
    s_waitcnt lgkmcnt(0)
    v_mfma_f32_32x32x16_bf16 v[0:15], v[112:115], v[116:119], v[0:15]
    ds_read_b128 v[144:147], v179
    ds_read_b64_tr_b16 v[148:149], v180 offset:9216
    ds_read_b64_tr_b16 v[150:151], v180 offset:9984
    v_mfma_f32_32x32x16_bf16 v[16:31], v[112:115], v[120:123], v[16:31]
    ds_read_b64_tr_b16 v[152:153], v180 offset:23680
    ds_read_b64_tr_b16 v[154:155], v180 offset:24448
    ds_read_b64_tr_b16 v[156:157], v180 offset:9280
    v_mfma_f32_32x32x16_bf16 v[32:47], v[112:115], v[124:127], v[32:47]
    ds_read_b64_tr_b16 v[158:159], v180 offset:10048
    ds_read_b64_tr_b16 v[160:161], v180 offset:23744
    v_mfma_f32_32x32x16_bf16 v[48:63], v[112:115], v[128:131], v[48:63]
    ds_read_b64_tr_b16 v[162:163], v180 offset:24512
    ds_read_b64_tr_b16 v[164:165], v180 offset:9344
    ds_read_b64_tr_b16 v[166:167], v180 offset:10112
    v_mfma_f32_32x32x16_bf16 v[64:79], v[112:115], v[132:135], v[64:79]
    ds_read_b64_tr_b16 v[168:169], v180 offset:23808
    ds_read_b64_tr_b16 v[170:171], v180 offset:24576
    v_mfma_f32_32x32x16_bf16 v[80:95], v[112:115], v[136:139], v[80:95]
    s_add_u32 s43, s43, 1
    s_cmp_eq_u32 s43, 3
    s_cselect_b32 s45, -32768, s47
    s_cselect_b32 s43, 0, s43
    s_lshl_b32 s46, s45, 1
    v_add_u32 v176, s45, v176
    v_add_u32 v177, s45, v177
    v_add_u32 v178, s45, v178
    v_add_u32 v179, s45, v179
    v_add_u32 v180, s46, v180
    s_add_u32 s42, s42, 1
    s_cmp_lt_u32 s42, 8
    s_cbranch_scc1 cd_loop
    s_waitcnt lgkmcnt(0)
    s_barrier
    v_mfma_f32_32x32x16_bf16 v[0:15], v[144:147], v[148:151], v[0:15]
    v_mfma_f32_32x32x16_bf16 v[16:31], v[144:147], v[152:155], v[16:31]
    v_mfma_f32_32x32x16_bf16 v[32:47], v[144:147], v[156:159], v[32:47]
    v_mfma_f32_32x32x16_bf16 v[48:63], v[144:147], v[160:163], v[48:63]
    v_mfma_f32_32x32x16_bf16 v[64:79], v[144:147], v[164:167], v[64:79]
    v_mfma_f32_32x32x16_bf16 v[80:95], v[144:147], v[168:171], v[80:95]
    s_lshl_b32 s21, s18, 7
    s_add_u32 s21, s21, 161792
    v_lshl_add_u32 v206, v204, 2, s21
    v_lshlrev_b32 v211, 2, v204
    v_add_u32 v211, 162816, v211
    ds_read_b32 v207, v206
    v_mov_b32 v201, 161600
    ds_read_b64 v[202:203], v201
    v_lshl_add_u32 v208, v205, 4, s21
    ds_read_b128 v[184:187], v208 offset:512
    ds_read_b128 v[188:191], v208 offset:544
    ds_read_b128 v[192:195], v208 offset:576
    ds_read_b128 v[196:199], v208 offset:608
    ds_read_b32 v114, v211 offset:0
    ds_read_b32 v118, v211 offset:128
    ds_read_b32 v122, v211 offset:256
    ds_read_b32 v126, v211 offset:384
    ds_read_b32 v130, v211 offset:512
    ds_read_b32 v134, v211 offset:640
    v_cmp_gt_u32 vcc, 32, v200
    v_mov_b32 v214, 0
    v_mov_b32 v215, 0
    s_waitcnt lgkmcnt(0)
    v_xor_b32 v207, 0x80000000, v207
    v_cndmask_b32 v207, 0, v207, vcc
    v_and_b32 v208, 0xffff0000, v207
    v_sub_f32 v209, v207, v208
    v_cvt_pk_bf16_f32 v212, v208, v209
    v_mov_b32 v213, v212
    v_and_b32 v115, 0xffff0000, v114
    v_and_b32 v119, 0xffff0000, v118
    v_and_b32 v123, 0xffff0000, v122
    v_and_b32 v127, 0xffff0000, v126
    v_and_b32 v131, 0xffff0000, v130
    v_and_b32 v135, 0xffff0000, v134
    v_sub_f32 v114, v114, v115
    v_sub_f32 v118, v118, v119
    v_sub_f32 v122, v122, v123
    v_sub_f32 v126, v126, v127
    v_sub_f32 v130, v130, v131
    v_sub_f32 v134, v134, v135
    v_cvt_pk_bf16_f32 v112, v115, v115
    v_cvt_pk_bf16_f32 v113, v114, v114
    v_mov_b32 v114, 0
    v_cvt_pk_bf16_f32 v116, v119, v119
    v_cvt_pk_bf16_f32 v117, v118, v118
    v_mov_b32 v118, 0
    v_cvt_pk_bf16_f32 v120, v123, v123
    v_cvt_pk_bf16_f32 v121, v122, v122
    v_mov_b32 v122, 0
    v_cvt_pk_bf16_f32 v124, v127, v127
    v_cvt_pk_bf16_f32 v125, v126, v126
    v_mov_b32 v126, 0
    v_cvt_pk_bf16_f32 v128, v131, v131
    v_cvt_pk_bf16_f32 v129, v130, v130
    v_mov_b32 v130, 0
    v_cvt_pk_bf16_f32 v132, v135, v135
    v_cvt_pk_bf16_f32 v133, v134, v134
    v_mov_b32 v134, 0
    s_nop 1
    v_mfma_f32_32x32x16_bf16 v[0:15], v[212:215], v[112:115], v[0:15]
    v_mfma_f32_32x32x16_bf16 v[16:31], v[212:215], v[116:119], v[16:31]
    v_mfma_f32_32x32x16_bf16 v[32:47], v[212:215], v[120:123], v[32:47]
    v_mfma_f32_32x32x16_bf16 v[48:63], v[212:215], v[124:127], v[48:63]
    v_mfma_f32_32x32x16_bf16 v[64:79], v[212:215], v[128:131], v[64:79]
    v_mfma_f32_32x32x16_bf16 v[80:95], v[212:215], v[132:135], v[80:95]
    v_lshlrev_b32 v208, 9, v205
    v_lshl_add_u32 v208, v204, 2, v208
    s_lshl_b32 s21, s18, 12
    s_add_u32 s21, s21, 16384
    v_add_u32 v208, s21, v208
    v_add_u32 v209, 65536, v208
    s_nop 4
    v_pk_mul_f32 v[0:1], v[0:1], v[184:185]
    v_pk_mul_f32 v[2:3], v[2:3], v[186:187]
    v_pk_mul_f32 v[4:5], v[4:5], v[188:189]
    v_pk_mul_f32 v[6:7], v[6:7], v[190:191]
    v_pk_mul_f32 v[8:9], v[8:9], v[192:193]
    v_pk_mul_f32 v[10:11], v[10:11], v[194:195]
    v_pk_mul_f32 v[12:13], v[12:13], v[196:197]
    v_pk_mul_f32 v[14:15], v[14:15], v[198:199]
    v_pk_mul_f32 v[16:17], v[16:17], v[184:185]
    v_pk_mul_f32 v[18:19], v[18:19], v[186:187]
    v_pk_mul_f32 v[20:21], v[20:21], v[188:189]
    v_pk_mul_f32 v[22:23], v[22:23], v[190:191]
    v_pk_mul_f32 v[24:25], v[24:25], v[192:193]
    v_pk_mul_f32 v[26:27], v[26:27], v[194:195]
    v_pk_mul_f32 v[28:29], v[28:29], v[196:197]
    v_pk_mul_f32 v[30:31], v[30:31], v[198:199]
    v_pk_mul_f32 v[32:33], v[32:33], v[184:185]
    v_pk_mul_f32 v[34:35], v[34:35], v[186:187]
    v_pk_mul_f32 v[36:37], v[36:37], v[188:189]
    v_pk_mul_f32 v[38:39], v[38:39], v[190:191]
    v_pk_mul_f32 v[40:41], v[40:41], v[192:193]
    v_pk_mul_f32 v[42:43], v[42:43], v[194:195]
    v_pk_mul_f32 v[44:45], v[44:45], v[196:197]
    v_pk_mul_f32 v[46:47], v[46:47], v[198:199]
    v_pk_mul_f32 v[48:49], v[48:49], v[184:185]
    v_pk_mul_f32 v[50:51], v[50:51], v[186:187]
    v_pk_mul_f32 v[52:53], v[52:53], v[188:189]
    v_pk_mul_f32 v[54:55], v[54:55], v[190:191]
    v_pk_mul_f32 v[56:57], v[56:57], v[192:193]
    v_pk_mul_f32 v[58:59], v[58:59], v[194:195]
    v_pk_mul_f32 v[60:61], v[60:61], v[196:197]
    v_pk_mul_f32 v[62:63], v[62:63], v[198:199]
    v_pk_mul_f32 v[64:65], v[64:65], v[184:185]
    v_pk_mul_f32 v[66:67], v[66:67], v[186:187]
    v_pk_mul_f32 v[68:69], v[68:69], v[188:189]
    v_pk_mul_f32 v[70:71], v[70:71], v[190:191]
    v_pk_mul_f32 v[72:73], v[72:73], v[192:193]
    v_pk_mul_f32 v[74:75], v[74:75], v[194:195]
    v_pk_mul_f32 v[76:77], v[76:77], v[196:197]
    v_pk_mul_f32 v[78:79], v[78:79], v[198:199]
    v_pk_mul_f32 v[80:81], v[80:81], v[184:185]
    v_pk_mul_f32 v[82:83], v[82:83], v[186:187]
    v_pk_mul_f32 v[84:85], v[84:85], v[188:189]
    v_pk_mul_f32 v[86:87], v[86:87], v[190:191]
    v_pk_mul_f32 v[88:89], v[88:89], v[192:193]
    v_pk_mul_f32 v[90:91], v[90:91], v[194:195]
    v_pk_mul_f32 v[92:93], v[92:93], v[196:197]
    v_pk_mul_f32 v[94:95], v[94:95], v[198:199]
    v_cvt_pk_bf16_f32 v144, v0, v1
    v_cvt_pk_bf16_f32 v145, v2, v3
    v_cvt_pk_bf16_f32 v146, v4, v5
    v_cvt_pk_bf16_f32 v147, v6, v7
    v_cvt_pk_bf16_f32 v148, v8, v9
    v_cvt_pk_bf16_f32 v149, v10, v11
    v_cvt_pk_bf16_f32 v150, v12, v13
    v_cvt_pk_bf16_f32 v151, v14, v15
    v_cvt_pk_bf16_f32 v152, v16, v17
    v_cvt_pk_bf16_f32 v153, v18, v19
    v_cvt_pk_bf16_f32 v154, v20, v21
    v_cvt_pk_bf16_f32 v155, v22, v23
    v_cvt_pk_bf16_f32 v156, v24, v25
    v_cvt_pk_bf16_f32 v157, v26, v27
    v_cvt_pk_bf16_f32 v158, v28, v29
    v_cvt_pk_bf16_f32 v159, v30, v31
    s_nop 1
    v_mfma_f32_32x32x16_bf16 v[0:15], v[224:227], v[144:147], 0
    v_cvt_pk_bf16_f32 v160, v32, v33
    v_cvt_pk_bf16_f32 v161, v34, v35
    v_mfma_f32_32x32x16_bf16 v[16:31], v[224:227], v[152:155], 0
    v_cvt_pk_bf16_f32 v162, v36, v37
    v_cvt_pk_bf16_f32 v163, v38, v39
    v_mfma_f32_32x32x16_bf16 v[0:15], v[232:235], v[152:155], v[0:15]
    v_cvt_pk_bf16_f32 v164, v40, v41
    v_cvt_pk_bf16_f32 v165, v42, v43
    v_mfma_f32_32x32x16_bf16 v[16:31], v[240:243], v[144:147], v[16:31]
    v_cvt_pk_bf16_f32 v166, v44, v45
    v_cvt_pk_bf16_f32 v167, v46, v47
    v_mfma_f32_32x32x16_bf16 v[0:15], v[228:231], v[148:151], v[0:15]
    v_cvt_pk_bf16_f32 v168, v48, v49
    v_cvt_pk_bf16_f32 v169, v50, v51
    v_mfma_f32_32x32x16_bf16 v[16:31], v[228:231], v[156:159], v[16:31]
    v_cvt_pk_bf16_f32 v170, v52, v53
    v_cvt_pk_bf16_f32 v171, v54, v55
    v_mfma_f32_32x32x16_bf16 v[0:15], v[236:239], v[156:159], v[0:15]
    v_cvt_pk_bf16_f32 v172, v56, v57
    v_cvt_pk_bf16_f32 v173, v58, v59
    v_mfma_f32_32x32x16_bf16 v[16:31], v[244:247], v[148:151], v[16:31]
    v_cvt_pk_bf16_f32 v174, v60, v61
    v_cvt_pk_bf16_f32 v175, v62, v63
    s_nop 1
    v_mfma_f32_32x32x16_bf16 v[32:47], v[224:227], v[160:163], 0
    v_cvt_pk_bf16_f32 v144, v64, v65
    v_cvt_pk_bf16_f32 v145, v66, v67
    v_cvt_pk_bf16_f32 v146, v68, v69
    v_cvt_pk_bf16_f32 v147, v70, v71
    v_mfma_f32_32x32x16_bf16 v[48:63], v[224:227], v[168:171], 0
    v_cvt_pk_bf16_f32 v148, v72, v73
    v_cvt_pk_bf16_f32 v149, v74, v75
    v_cvt_pk_bf16_f32 v150, v76, v77
    v_cvt_pk_bf16_f32 v151, v78, v79
    v_mfma_f32_32x32x16_bf16 v[32:47], v[232:235], v[168:171], v[32:47]
    v_cvt_pk_bf16_f32 v152, v80, v81
    v_cvt_pk_bf16_f32 v153, v82, v83
    v_cvt_pk_bf16_f32 v154, v84, v85
    v_cvt_pk_bf16_f32 v155, v86, v87
    v_mfma_f32_32x32x16_bf16 v[48:63], v[240:243], v[160:163], v[48:63]
    v_cvt_pk_bf16_f32 v156, v88, v89
    v_cvt_pk_bf16_f32 v157, v90, v91
    v_cvt_pk_bf16_f32 v158, v92, v93
    v_cvt_pk_bf16_f32 v159, v94, v95
    v_mfma_f32_32x32x16_bf16 v[32:47], v[228:231], v[164:167], v[32:47]
    v_cvt_pk_bf16_f32 v0, v0, v16
    ds_write_b32 v208, v0 offset:0
    v_cvt_pk_bf16_f32 v1, v1, v17
    ds_write_b32 v208, v1 offset:128
    v_mfma_f32_32x32x16_bf16 v[48:63], v[228:231], v[172:175], v[48:63]
    v_cvt_pk_bf16_f32 v2, v2, v18
    ds_write_b32 v208, v2 offset:256
    v_cvt_pk_bf16_f32 v3, v3, v19
    ds_write_b32 v208, v3 offset:384
    v_mfma_f32_32x32x16_bf16 v[32:47], v[236:239], v[172:175], v[32:47]
    v_cvt_pk_bf16_f32 v4, v4, v20
    ds_write_b32 v208, v4 offset:1024
    v_cvt_pk_bf16_f32 v5, v5, v21
    ds_write_b32 v208, v5 offset:1152
    v_mfma_f32_32x32x16_bf16 v[48:63], v[244:247], v[164:167], v[48:63]
    v_cvt_pk_bf16_f32 v6, v6, v22
    ds_write_b32 v208, v6 offset:1280
    v_cvt_pk_bf16_f32 v7, v7, v23
    ds_write_b32 v208, v7 offset:1408
    s_nop 1
    v_mfma_f32_32x32x16_bf16 v[64:79], v[224:227], v[144:147], 0
    v_cvt_pk_bf16_f32 v8, v8, v24
    ds_write_b32 v208, v8 offset:2048
    v_cvt_pk_bf16_f32 v9, v9, v25
    ds_write_b32 v208, v9 offset:2176
    v_mfma_f32_32x32x16_bf16 v[80:95], v[224:227], v[152:155], 0
    v_cvt_pk_bf16_f32 v10, v10, v26
    ds_write_b32 v208, v10 offset:2304
    v_cvt_pk_bf16_f32 v11, v11, v27
    ds_write_b32 v208, v11 offset:2432
    v_mfma_f32_32x32x16_bf16 v[64:79], v[232:235], v[152:155], v[64:79]
    v_cvt_pk_bf16_f32 v12, v12, v28
    ds_write_b32 v208, v12 offset:3072
    v_cvt_pk_bf16_f32 v13, v13, v29
    ds_write_b32 v208, v13 offset:3200
    v_mfma_f32_32x32x16_bf16 v[80:95], v[240:243], v[144:147], v[80:95]
    v_cvt_pk_bf16_f32 v14, v14, v30
    ds_write_b32 v208, v14 offset:3328
    v_cvt_pk_bf16_f32 v15, v15, v31
    ds_write_b32 v208, v15 offset:3456
    v_mfma_f32_32x32x16_bf16 v[64:79], v[228:231], v[148:151], v[64:79]
    v_cvt_pk_bf16_f32 v32, v32, v48
    ds_write_b32 v209, v32 offset:0
    v_cvt_pk_bf16_f32 v33, v33, v49
    ds_write_b32 v209, v33 offset:128
    v_mfma_f32_32x32x16_bf16 v[80:95], v[228:231], v[156:159], v[80:95]
    v_cvt_pk_bf16_f32 v34, v34, v50
    ds_write_b32 v209, v34 offset:256
    v_cvt_pk_bf16_f32 v35, v35, v51
    ds_write_b32 v209, v35 offset:384
    v_mfma_f32_32x32x16_bf16 v[64:79], v[236:239], v[156:159], v[64:79]
    v_cvt_pk_bf16_f32 v36, v36, v52
    ds_write_b32 v209, v36 offset:1024
    v_cvt_pk_bf16_f32 v37, v37, v53
    ds_write_b32 v209, v37 offset:1152
    v_mfma_f32_32x32x16_bf16 v[80:95], v[244:247], v[148:151], v[80:95]
    v_cvt_pk_bf16_f32 v38, v38, v54
    ds_write_b32 v209, v38 offset:1280
    v_cvt_pk_bf16_f32 v39, v39, v55
    ds_write_b32 v209, v39 offset:1408
    v_cvt_pk_bf16_f32 v40, v40, v56
    ds_write_b32 v209, v40 offset:2048
    v_cvt_pk_bf16_f32 v41, v41, v57
    ds_write_b32 v209, v41 offset:2176
    v_cvt_pk_bf16_f32 v42, v42, v58
    ds_write_b32 v209, v42 offset:2304
    v_cvt_pk_bf16_f32 v43, v43, v59
    ds_write_b32 v209, v43 offset:2432
    v_cvt_pk_bf16_f32 v44, v44, v60
    ds_write_b32 v209, v44 offset:3072
    v_cvt_pk_bf16_f32 v45, v45, v61
    ds_write_b32 v209, v45 offset:3200
    v_cvt_pk_bf16_f32 v46, v46, v62
    ds_write_b32 v209, v46 offset:3328
    v_cvt_pk_bf16_f32 v47, v47, v63
    ds_write_b32 v209, v47 offset:3456
    v_cvt_pk_bf16_f32 v64, v64, v80
    ds_write_b32 v209, v64 offset:16384
    v_cvt_pk_bf16_f32 v65, v65, v81
    ds_write_b32 v209, v65 offset:16512
    v_cvt_pk_bf16_f32 v66, v66, v82
    ds_write_b32 v209, v66 offset:16640
    v_cvt_pk_bf16_f32 v67, v67, v83
    ds_write_b32 v209, v67 offset:16768
    v_cvt_pk_bf16_f32 v68, v68, v84
    ds_write_b32 v209, v68 offset:17408
    v_cvt_pk_bf16_f32 v69, v69, v85
    ds_write_b32 v209, v69 offset:17536
    v_cvt_pk_bf16_f32 v70, v70, v86
    ds_write_b32 v209, v70 offset:17664
    v_cvt_pk_bf16_f32 v71, v71, v87
    ds_write_b32 v209, v71 offset:17792
    v_cvt_pk_bf16_f32 v72, v72, v88
    ds_write_b32 v209, v72 offset:18432
    v_cvt_pk_bf16_f32 v73, v73, v89
    ds_write_b32 v209, v73 offset:18560
    v_cvt_pk_bf16_f32 v74, v74, v90
    ds_write_b32 v209, v74 offset:18688
    v_cvt_pk_bf16_f32 v75, v75, v91
    ds_write_b32 v209, v75 offset:18816
    v_cvt_pk_bf16_f32 v76, v76, v92
    ds_write_b32 v209, v76 offset:19456
    v_cvt_pk_bf16_f32 v77, v77, v93
    ds_write_b32 v209, v77 offset:19584
    v_cvt_pk_bf16_f32 v78, v78, v94
    ds_write_b32 v209, v78 offset:19712
    v_cvt_pk_bf16_f32 v79, v79, v95
    ds_write_b32 v209, v79 offset:19840
    s_waitcnt lgkmcnt(0)
    s_barrier
    ds_read2st64_b32 v[0:1], v216 offset0:0 offset1:16
    ds_read2st64_b32 v[2:3], v216 offset0:32 offset1:48
    ds_read2st64_b32 v[4:5], v216 offset0:1 offset1:17
    ds_read2st64_b32 v[6:7], v216 offset0:33 offset1:49
    ds_read2st64_b32 v[8:9], v218 offset0:0 offset1:16
    ds_read2st64_b32 v[10:11], v218 offset0:32 offset1:48
    ds_read2st64_b32 v[12:13], v218 offset0:1 offset1:17
    ds_read2st64_b32 v[14:15], v218 offset0:33 offset1:49
    ds_read2st64_b32 v[16:17], v218 offset0:64 offset1:80
    ds_read2st64_b32 v[18:19], v218 offset0:96 offset1:112
    ds_read2st64_b32 v[20:21], v218 offset0:65 offset1:81
    ds_read2st64_b32 v[22:23], v218 offset0:97 offset1:113
    s_waitcnt lgkmcnt(10)
    buffer_store_dwordx4 v[0:3], v217, s[56:59], s52 offen offset:0 sc1
    s_waitcnt lgkmcnt(8)
    buffer_store_dwordx4 v[4:7], v217, s[56:59], s53 offen offset:0 sc1
    s_waitcnt lgkmcnt(6)
    buffer_store_dwordx4 v[8:11], v217, s[56:59], s52 offen offset:512 sc1
    s_waitcnt lgkmcnt(4)
    buffer_store_dwordx4 v[12:15], v217, s[56:59], s53 offen offset:512 sc1
    s_waitcnt lgkmcnt(2)
    s_mov_b32 exec_lo, s54
    s_mov_b32 exec_hi, s54
    buffer_store_dwordx4 v[16:19], v217, s[56:59], s52 offen offset:1024 sc1
    s_waitcnt lgkmcnt(0)
    buffer_store_dwordx4 v[20:23], v217, s[56:59], s53 offen offset:1024 sc1
    s_mov_b64 exec, -1
    v_mov_b32 v201, 0
    s_cmp_eq_u32 s3, 0
    s_waitcnt vmcnt(0)
    s_barrier
    s_cbranch_scc0 cd_nf
    s_mov_b64 exec, 1
    buffer_store_dwordx2 v[202:203], v201, s[56:59], s55 offen sc1
    s_mov_b64 exec, -1
cd_nf:
    s_setprio 0
    s_branch p2_a
k_exit:
    s_endpgm
    s_endpgm
    s_endpgm
    s_endpgm
    s_endpgm
    s_endpgm
    s_endpgm
    s_endpgm
    s_endpgm
    s_endpgm
    s_endpgm
    s_endpgm
    s_endpgm
    s_endpgm
    s_endpgm
    s_endpgm
    s_endpgm
    s_endpgm
    s_endpgm
    s_endpgm
    s_endpgm
    s_endpgm
    s_endpgm
    s_endpgm
    s_endpgm
    s_endpgm
    s_endpgm
    s_endpgm
    s_endpgm
    s_endpgm
    s_endpgm
    s_endpgm
    s_endpgm
    s_endpgm
    s_endpgm
    s_endpgm
    s_endpgm
    s_endpgm
    s_endpgm
    s_endpgm
    s_endpgm
    s_endpgm
    s_endpgm
    s_endpgm
    s_endpgm
    s_endpgm
    s_endpgm
    s_endpgm
    s_endpgm
    s_endpgm
    s_endpgm
    s_endpgm
    s_endpgm
    s_endpgm
    s_endpgm
    s_endpgm
    s_endpgm
    s_endpgm
    s_endpgm
    s_endpgm
    s_endpgm
    s_endpgm
    s_endpgm
    s_endpgm
    s_endpgm
    s_endpgm
    s_endpgm
    s_endpgm
    s_endpgm
    s_endpgm
    s_endpgm
    s_endpgm
    s_endpgm
    s_endpgm
    s_endpgm
    s_endpgm
    s_endpgm
    s_endpgm
    s_endpgm
    s_endpgm
    s_endpgm
    s_endpgm
    s_endpgm
    s_endpgm
    s_endpgm
    s_endpgm
    s_endpgm
    s_endpgm
    s_endpgm
    s_endpgm
    s_endpgm
    s_endpgm
    s_endpgm
    s_endpgm
    s_endpgm
    s_endpgm
    s_endpgm
    s_endpgm
    s_endpgm
    s_endpgm
    s_endpgm
    s_endpgm
    s_endpgm
    s_endpgm
    s_endpgm
    s_endpgm
    s_endpgm
    s_endpgm
    s_endpgm
    s_endpgm
    s_endpgm
    s_endpgm
    s_endpgm
    s_endpgm
    s_endpgm
    s_endpgm
    s_endpgm
    s_endpgm
    s_endpgm
    s_endpgm
    s_endpgm
    s_endpgm
    s_endpgm
    s_endpgm
    s_endpgm
    s_endpgm
    s_endpgm
    s_endpgm
    s_endpgm
    s_endpgm
    s_endpgm
    s_endpgm
    s_endpgm
    s_endpgm
    s_endpgm
    s_endpgm
    s_endpgm
    s_endpgm
    s_endpgm
    s_endpgm
    s_endpgm
    s_endpgm
    s_endpgm
    s_endpgm
    s_endpgm
    s_endpgm
    s_endpgm
    s_endpgm
    s_endpgm
    s_endpgm
    s_endpgm
    s_endpgm
    s_endpgm
    s_endpgm
    s_endpgm
    s_endpgm
    s_endpgm
    s_endpgm
    s_endpgm
    s_endpgm
    s_endpgm
    s_endpgm
    s_endpgm
    s_endpgm
    s_endpgm
    s_endpgm
    s_endpgm
    s_endpgm
    s_endpgm
    s_endpgm
    s_endpgm
    s_endpgm
    s_endpgm
    s_endpgm
    s_endpgm
    s_endpgm
    s_endpgm
    s_endpgm
    s_endpgm
    s_endpgm
    s_endpgm
    s_endpgm
    s_endpgm
    s_endpgm
    s_endpgm
    s_endpgm
    s_endpgm
    s_endpgm
    s_endpgm
    s_endpgm
    s_endpgm
    s_endpgm
    s_endpgm
    s_endpgm
    s_endpgm
    s_endpgm
    s_endpgm
    s_endpgm
    s_endpgm
    s_endpgm
    s_endpgm
    s_endpgm
    s_endpgm
    s_endpgm
    s_endpgm
    s_endpgm
    s_endpgm
    s_endpgm
    s_endpgm
    s_endpgm
    s_endpgm
    s_endpgm
    s_endpgm
    s_endpgm
    s_endpgm
    s_endpgm
    s_endpgm
    s_endpgm
    s_endpgm
    s_endpgm
    s_endpgm
    s_endpgm
    s_endpgm
    s_endpgm
    s_endpgm
    s_endpgm
    s_endpgm
    s_endpgm
    s_endpgm
    s_endpgm
    s_endpgm
    s_endpgm
    s_endpgm
    s_endpgm
    s_endpgm
    s_endpgm
    s_endpgm
    s_endpgm
    s_endpgm
    s_endpgm
    s_endpgm
    s_endpgm
    s_endpgm
    s_endpgm
    s_endpgm
    s_endpgm
    s_endpgm
    s_endpgm
    s_endpgm
    s_endpgm
    s_endpgm
    s_endpgm
    s_endpgm
    s_endpgm
    s_endpgm
    s_endpgm
    s_endpgm
    s_endpgm
    s_endpgm
    s_endpgm
    s_endpgm
    s_endpgm
    s_endpgm
    s_endpgm
    s_endpgm
    s_endpgm
    s_endpgm
    s_endpgm
    s_endpgm
    s_endpgm
    s_endpgm
    s_endpgm
    s_endpgm
    s_endpgm
    s_endpgm
    s_endpgm
    s_endpgm
    s_endpgm
    s_endpgm
    s_endpgm
    s_endpgm
    s_endpgm
    s_endpgm
    s_endpgm
    s_endpgm
    s_endpgm
    s_endpgm
    s_endpgm
    s_endpgm
    s_endpgm
    s_endpgm
    s_endpgm
    s_endpgm
    s_endpgm
    s_endpgm
    s_endpgm
    s_endpgm
    s_endpgm
    s_endpgm
    s_endpgm
    s_endpgm
    s_endpgm
    s_endpgm
    s_endpgm
    s_endpgm
    s_endpgm
    s_endpgm
    s_endpgm
    s_endpgm
    s_endpgm
    s_endpgm
    s_endpgm
    s_endpgm
    s_endpgm
    s_endpgm
    s_endpgm
    s_endpgm
    s_endpgm
    s_endpgm
    s_endpgm
    s_endpgm
    s_endpgm
    s_endpgm
    s_endpgm
    s_endpgm
    s_endpgm
    s_endpgm
    s_endpgm
    s_endpgm
    s_endpgm
    s_endpgm
    s_endpgm
    s_endpgm
    s_endpgm
    s_endpgm
    s_endpgm
    s_endpgm
    s_endpgm
    s_endpgm
    s_endpgm
    s_endpgm
    s_endpgm
    s_endpgm
    s_endpgm
    s_endpgm
    s_endpgm
    s_endpgm
    s_endpgm
    s_endpgm
    s_endpgm
    s_endpgm
    s_endpgm
    s_endpgm
    s_endpgm
    s_endpgm
    s_endpgm
    s_endpgm
    s_endpgm
    s_endpgm
    s_endpgm
    s_endpgm
    s_endpgm
    s_endpgm
    s_endpgm
    s_endpgm
    s_endpgm
    s_endpgm
    s_endpgm
    s_endpgm
    s_endpgm
    s_endpgm
    s_endpgm
    s_endpgm
    s_endpgm
    s_endpgm
    s_endpgm
    s_endpgm
    s_endpgm
    s_endpgm
    s_endpgm
    s_endpgm
    s_endpgm
    s_endpgm
    s_endpgm
k_end:
    s_endpgm
.section .rodata,"a"
.p2align 6
.amdhsa_kernel recurrent_scan__spectral_fnet__glu_gated_swiglu__prompt_kernel
  .amdhsa_next_free_vgpr 256
  .amdhsa_next_free_sgpr 102
  .amdhsa_accum_offset 256
  .amdhsa_group_segment_fixed_size 0
  .amdhsa_kernarg_size 96
  .amdhsa_user_sgpr_count 2
  .amdhsa_user_sgpr_kernarg_segment_ptr 1
  .amdhsa_system_sgpr_workgroup_id_x 1
.end_amdhsa_kernel
```
